```python
import torch

def _softmax(x, axis=-1):
    return torch.softmax(x, dim=axis)
def _gelu(x):
    return torch.nn.functional.gelu(x, approximate="tanh")
def _silu(x):
    return torch.nn.functional.silu(x)
def _sigmoid(x):
    return torch.sigmoid(x)
def _layernorm(x, axis=-1, eps=1e-5):
    m = x.mean(dim=axis, keepdim=True)
    v = x.var(dim=axis, keepdim=True, unbiased=False)
    return (x - m) / torch.sqrt(v + eps)
def _scatter_add(tgt, idx, src, axis=0):
    return tgt.clone().index_add_(axis, idx, src)
def _segment_sum(src, seg, n):
    out = torch.zeros((n,) + src.shape[1:], dtype=src.dtype)
    return out.index_add_(0, seg, src)
def _pad(x, pw):
    flat = tuple(v for pair in reversed(pw) for v in pair)
    return torch.nn.functional.pad(x, flat)

kernel_name = 'parallel_sum__ssm_conv_s4__dense_activation_gelu__prompt'

def setup_inputs():

    _w = (lambda a: (lambda t: t.to(torch.bfloat16) if t.is_floating_point() else t)(torch.as_tensor(a)))
    def _A_setup():
        B, L, D, N = 1, 2048, 512, 128
        A_re = -(lambda _x: torch.exp(torch.as_tensor(_x)))((lambda *s: torch.randn(*s, dtype=torch.bfloat16) * 12.8)(D, N))
        A_im = torch.pi * (lambda *s: torch.randn(*s, dtype=torch.bfloat16) * 0.05)(D, N)
        B_re = (lambda *s: torch.randn(*s, dtype=torch.bfloat16) * 0.1)(D, N)
        B_im = (lambda *s: torch.randn(*s, dtype=torch.bfloat16) * 0.1)(D, N)
        C_re = (lambda *s: torch.randn(*s, dtype=torch.bfloat16) * 0.2)(D, N)
        C_im = (lambda *s: torch.randn(*s, dtype=torch.bfloat16) * 0.2)(D, N)
        log_dt = (lambda *s: torch.randn(*s, dtype=torch.bfloat16) * 0.05)(D) * 0.5 - 4.0
        Dskip = (lambda *s: torch.randn(*s, dtype=torch.bfloat16) * 0.05)(D)
        return {
            "u": _w((lambda *s: torch.randn(*s, dtype=torch.bfloat16) * 0.05)(B, L, D)),
            "A_re": _w(A_re),
            "A_im": _w(A_im),
            "B_re": _w(B_re),
            "B_im": _w(B_im),
            "C_re": _w(C_re),
            "C_im": _w(C_im),
            "log_dt": _w(log_dt),
            "Dskip": _w(Dskip),
        }
    _A_in = _A_setup()

    def _B_setup():
        B, S, D, F = 1, 2048, 512, 1792
        return {
            "x": _w((lambda *s: torch.randn(*s, dtype=torch.bfloat16) * 0.05)(B, S, D)),
            "w1": _w((lambda *s: torch.randn(*s, dtype=torch.bfloat16) * 0.8)(D, F) * (D ** -0.5)),
            "b1": _w((lambda *s: torch.randn(*s, dtype=torch.bfloat16) * 12.8)(F) * 0.01),
            "w2": _w((lambda *s: torch.randn(*s, dtype=torch.bfloat16) * 0.8)(F, D) * (F ** -0.5)),
            "b2": _w((lambda *s: torch.randn(*s, dtype=torch.bfloat16) * 12.8)(D) * 0.01),
        }
    _B_in = _B_setup()

    return {
        "A_u": _A_in["u"],
        "A_A_re": _A_in["A_re"],
        "A_A_im": _A_in["A_im"],
        "A_B_re": _A_in["B_re"],
        "A_B_im": _A_in["B_im"],
        "A_C_re": _A_in["C_re"],
        "A_C_im": _A_in["C_im"],
        "A_log_dt": _A_in["log_dt"],
        "A_Dskip": _A_in["Dskip"],
        "B_x": _B_in["x"],
        "B_w1": _B_in["w1"],
        "B_b1": _B_in["b1"],
        "B_w2": _B_in["w2"],
        "B_b2": _B_in["b2"],
    }

def reference(A_u, A_A_re, A_A_im, A_B_re, A_B_im, A_C_re, A_C_im, A_log_dt, A_Dskip, B_x, B_w1, B_b1, B_w2, B_b2):
    def _A_ref(u, A_re, A_im, B_re, B_im, C_re, C_im, log_dt, Dskip):
        Bsz, L, D = u.shape
        dt = torch.exp(log_dt)[:, None]
        A = A_re + 1j * A_im
        Bc = B_re + 1j * B_im
        Cc = C_re + 1j * C_im
        logdA = dt * A
        dB = dt * Bc
        l = (lambda x, dt: x.to(dt))(torch.arange(L), A_re.dtype)
        P = torch.exp(logdA[:, :, None] * l[None, None, :])
        K = torch.einsum("dn,dnl,dn->dl", Cc, P, dB).real
        L2 = 2 * L
        Kp = _pad(K, ((0, 0), (0, L)))
        up = (lambda x, *d: x.permute(*d))(u, 0, 2, 1)
        up = _pad(up, ((0, 0), (0, 0), (0, L)))
        Kf = (lambda x, axes=(-2,-1): torch.fft.rfft2(x.float(), dim=axes))(Kp[:, None, :], axes=(-2, -1))
        Uf = (lambda x, axes=(-2,-1): torch.fft.rfft2(x.float(), dim=axes))(up[:, :, None, :], axes=(-2, -1))
        Yf = Uf * Kf[None, :, :, :]
        y = (lambda x, s, axes=(-2,-1): torch.fft.irfft2(x, s=s, dim=axes).to(torch.bfloat16))(Yf, (1, L2), axes=(-2, -1))[:, :, 0, :L]
        y = (lambda x, *d: x.permute(*d))(y, 0, 2, 1) + u * Dskip[None, None, :]
        return y

    def _B_ref(x, w1, b1, w2, b2):
        h = torch.einsum("bsd,df->bsf", x, w1) + b1
        h = _gelu(h)
        return torch.einsum("bsf,fd->bsd", h, w2) + b2

    x = A_u
    xn = _layernorm(x, axis=-1)
    return x + _A_ref(xn, A_A_re, A_A_im, A_B_re, A_B_im, A_C_re, A_C_im, A_log_dt, A_Dskip) + _B_ref(xn, B_w1, B_b1, B_w2, B_b2)
```

```asm
; @launch grid=(256,1,1) block=(512,1,1) lds=163840
.amdgcn_target "amdgcn-amd-amdhsa--gfx950"
.text
.globl parallel_sum__ssm_conv_s4__dense_activation_gelu__prompt_kernel
.p2align 8
.type parallel_sum__ssm_conv_s4__dense_activation_gelu__prompt_kernel,@function
parallel_sum__ssm_conv_s4__dense_activation_gelu__prompt_kernel:
  s_load_dwordx16 s[16:31], s[0:1], 0
  s_load_dwordx16 s[32:47], s[0:1], 64
  s_load_dwordx2 s[48:49], s[0:1], 128
  s_cmp_ge_u32 s2, 256
  s_cbranch_scc1 L_END
  v_lshrrev_b32 v1, 6, v0
  v_and_b32 v0, 63, v0
  v_readfirstlane_b32 s3, v1
  s_nop 0
  s_lshl_b32 s11, s3, 8
  s_add_u32 s11, s11, s2
  s_cmp_lg_u32 s11, 224
  s_cbranch_scc1 L_NONN
  s_memrealtime s[50:51]
  v_lshlrev_b32 v64, 7, v0
  v_add_u32 v64, 15269888, v64
  v_mov_b32 v65, 0
  v_lshlrev_b32 v66, 6, v0
  s_waitcnt lgkmcnt(0)
  s_mul_i32 s11, s50, 0x9E3779B1
  s_or_b32 s11, s11, 1
  v_mov_b32 v67, s11
  s_mov_b64 exec, 3
  global_store_dword v66, v67, s[46:47] sc1
  s_mov_b64 exec, -1
  global_store_dword v64, v65, s[48:49] sc1
  v_add_u32 v64, 0x2000, v64
  global_store_dword v64, v65, s[48:49] sc1
  v_add_u32 v64, 0x2000, v64
  global_store_dword v64, v65, s[48:49] sc1
  v_add_u32 v64, 0x2000, v64
  s_waitcnt vmcnt(0)
  s_mov_b64 exec, 12
  global_store_dword v66, v67, s[46:47] sc1
  s_mov_b64 exec, -1
L_NONN:
  s_and_b32 s4, s2, 7
  s_lshr_b32 s5, s2, 3
  s_lshr_b32 s11, s5, 3
  s_lshl_b32 s8, s4, 2
  s_add_u32 s8, s8, s11
  s_and_b32 s9, s5, 7
  s_mov_b32 s10, 0
  s_getpc_b64 s[14:15]
L_PC:
  s_sub_u32 s14, s14, L_PC-parallel_sum__ssm_conv_s4__dense_activation_gelu__prompt_kernel
  s_subb_u32 s15, s15, 0
  s_cmp_lg_u32 s3, 3
  s_cbranch_scc1 L_NOWARM
  s_lshl_b32 s11, s9, 7
  v_lshlrev_b32 v2, 10, v0
  v_add_u32 v2, s11, v2
  v_min_u32 v2, L_END-parallel_sum__ssm_conv_s4__dense_activation_gelu__prompt_kernel, v2
  v_mov_b32 v3, s15
  v_add_co_u32 v2, vcc, s14, v2
  s_nop 1
  v_addc_co_u32 v3, vcc, 0, v3, vcc
  global_load_dword v95, v[2:3], off
L_NOWARM:
  s_min_u32 s13, s5, 27
  s_mul_i32 s11, s13, 37
  s_lshr_b32 s11, s11, 8
  s_mul_i32 s12, s11, 7
  s_sub_u32 s12, s13, s12
  s_lshr_b32 s6, s4, 1
  s_lshl_b32 s6, s6, 2
  s_add_u32 s6, s6, s11
  s_and_b32 s7, s4, 1
  s_mul_i32 s7, s7, 7
  s_add_u32 s7, s7, s12
  s_lshl_b32 s97, s11, 1
  s_add_u32 s97, s97, s12
  s_bfe_u32 s11, s4, 0x10001
  s_add_u32 s97, s97, s11
  s_cmp_ge_u32 s3, 4
  s_cbranch_scc1 L_AUX
  s_cmp_ge_u32 s5, 28
  s_cbranch_scc1 L_XC
  s_mov_b32 s68, s3
  v_mov_b32 v147, 0
  v_lshlrev_b32 v146, 4, v0
  s_lshl_b32 s11, s4, 8
  s_lshl_b32 s12, s5, 3
  s_add_u32 s11, s11, s12
  s_lshl_b32 s12, s68, 1
  s_add_u32 s13, s11, s12
  v_lshrrev_b32 v121, 5, v0
  v_add_u32 v121, s13, v121
  v_and_b32 v122, 31, v0
  v_lshlrev_b32 v122, 4, v122
  v_lshl_add_u32 v122, v121, 10, v122
  v_lshlrev_b32 v139, 3, v121
  v_add_u32 v139, 14680064, v139
  v_lshrrev_b32 v117, 5, v0
  v_bfe_u32 v145, v0, 2, 2
  v_lshl_add_u32 v117, v117, 2, v145
  v_lshlrev_b32 v117, 6, v117
  v_bfe_u32 v145, v0, 4, 1
  v_lshl_add_u32 v117, v145, 5, v117
  v_and_b32 v145, 3, v0
  v_lshl_add_u32 v117, v145, 3, v117
  s_waitcnt lgkmcnt(0)
  global_load_dwordx4 v[148:151], v122, s[16:17]
  global_load_dwordx4 v[152:155], v122, s[16:17] offset:512
  s_lshr_b32 s68, s3, 1
  s_and_b32 s69, s3, 1
  v_and_b32 v4, 31, v0
  s_lshl_b32 s11, s69, 6
  v_add_u32 v4, s11, v4
  v_lshrrev_b32 v5, 5, v0
  v_bfe_u32 v6, v0, 1, 3
  v_xor_b32 v6, v6, v5
  v_lshlrev_b32 v6, 4, v6
  v_lshl_add_u32 v48, v4, 7, v6
  v_xor_b32 v49, 32, v48
  v_xor_b32 v50, 64, v48
  v_xor_b32 v51, 96, v48
  v_add_u32 v52, 0x10000, v48
  v_add_u32 v53, 0x10000, v49
  v_add_u32 v54, 0x10000, v50
  v_add_u32 v55, 0x10000, v51
  v_bfe_u32 v4, v0, 2, 2
  v_lshl_add_u32 v6, v5, 3, v4
  v_bfe_u32 v7, v0, 4, 1
  v_lshlrev_b32 v7, 1, v7
  v_bfe_u32 v8, v0, 1, 1
  v_add_u32 v7, v7, v8
  s_lshl_b32 s11, s68, 3
  v_add_u32 v7, s11, v7
  v_lshlrev_b32 v4, 2, v4
  v_xor_b32 v7, v7, v4
  v_lshlrev_b32 v7, 4, v7
  v_lshl_add_u32 v7, v6, 8, v7
  v_and_b32 v8, 1, v0
  v_lshl_add_u32 v7, v8, 3, v7
  s_lshl_b32 s11, s69, 6
  v_xor_b32 v7, s11, v7
  v_add_u32 v56, 16384, v7
  v_xor_b32 v57, 64, v56
  v_add_u32 v58, 0x10000, v56
  v_add_u32 v59, 0x10000, v57
  v_and_b32 v4, 15, v0
  v_bfe_u32 v5, v0, 4, 1
  v_cmp_eq_u32 vcc, v4, v5
  v_mov_b32 v5, 0x3f803f80
  s_nop 0
  v_cndmask_b32 v8, 0, v5, vcc
  v_cndmask_b32 v9, 0, v5, vcc
  v_cndmask_b32 v10, 0, v5, vcc
  v_cndmask_b32 v11, 0, v5, vcc
  v_lshlrev_b32 v60, 4, v0
  s_waitcnt vmcnt(0)
  s_mov_b32 s68, s3
  s_mov_b32 s60, s40
  s_and_b32 s61, s41, 0xffff
  s_mov_b32 s62, 1835008
  s_mov_b32 s63, 0x00020000
  v_lshrrev_b32 v119, 2, v0
  v_and_b32 v120, 3, v0
  v_lshlrev_b32 v120, 4, v120
  v_lshl_add_u32 v119, v119, 10, v120
  s_and_b32 s11, s5, 1
  s_lshl_b32 s12, s4, 1
  s_add_u32 s50, s11, s12
  s_lshr_b32 s11, s5, 1
  s_mul_i32 s51, s11, 7
  s_lshl_b32 s11, s68, 1
  s_add_u32 s11, s11, 0
  s_min_u32 s100, s11, 6
  s_lshl_b32 s11, s100, 10
  s_add_u32 m0, s11, 131072
  s_add_u32 s11, s51, s100
  s_lshl_b32 s11, s11, 14
  s_lshl_b32 s12, s50, 6
  s_add_u32 s11, s11, s12
  buffer_load_dwordx4 v119, s[60:63], s11 offen lds
  s_lshl_b32 s11, s68, 1
  s_add_u32 s11, s11, 1
  s_min_u32 s101, s11, 6
  s_lshl_b32 s11, s101, 10
  s_add_u32 m0, s11, 131072
  s_add_u32 s11, s51, s101
  s_lshl_b32 s11, s11, 14
  s_lshl_b32 s12, s50, 6
  s_add_u32 s11, s11, s12
  buffer_load_dwordx4 v119, s[60:63], s11 offen lds
  s_mov_b32 s64, s48
  s_and_b32 s65, s49, 0xffff
  s_mov_b32 s66, 268435456
  s_mov_b32 s67, 0x00020000
  s_mov_b32 s92, s46
  s_mov_b32 s93, s47
  s_lshr_b32 s68, s3, 1
  s_load_dword s10, s[92:93], 0
  v_lshlrev_b32 v156, 16, v148
  v_and_b32 v157, 0xffff0000, v148
  v_lshlrev_b32 v158, 16, v149
  v_and_b32 v159, 0xffff0000, v149
  v_lshlrev_b32 v160, 16, v150
  v_and_b32 v161, 0xffff0000, v150
  v_lshlrev_b32 v162, 16, v151
  v_and_b32 v163, 0xffff0000, v151
  v_lshlrev_b32 v164, 16, v152
  v_and_b32 v165, 0xffff0000, v152
  v_lshlrev_b32 v166, 16, v153
  v_and_b32 v167, 0xffff0000, v153
  v_lshlrev_b32 v168, 16, v154
  v_and_b32 v169, 0xffff0000, v154
  v_lshlrev_b32 v170, 16, v155
  v_and_b32 v171, 0xffff0000, v155
  v_add_f32 v172, v156, v157
  v_add_f32 v173, v158, v159
  v_add_f32 v172, v172, v160
  v_add_f32 v173, v173, v161
  v_add_f32 v172, v172, v162
  v_add_f32 v173, v173, v163
  v_add_f32 v172, v172, v164
  v_add_f32 v173, v173, v165
  v_add_f32 v172, v172, v166
  v_add_f32 v173, v173, v167
  v_add_f32 v172, v172, v168
  v_add_f32 v173, v173, v169
  v_add_f32 v172, v172, v170
  v_add_f32 v173, v173, v171
  v_add_f32 v172, v172, v173
  s_nop 1
  v_add_f32_dpp v172, v172, v172 quad_perm:[1,0,3,2] row_mask:0xf bank_mask:0xf
  s_nop 1
  v_add_f32_dpp v172, v172, v172 quad_perm:[2,3,0,1] row_mask:0xf bank_mask:0xf
  s_nop 1
  v_add_f32_dpp v172, v172, v172 row_half_mirror row_mask:0xf bank_mask:0xf
  s_nop 1
  v_add_f32_dpp v172, v172, v172 row_mirror row_mask:0xf bank_mask:0xf
  v_mov_b32 v173, v172
  s_nop 1
  v_permlane16_swap_b32 v172, v173
  v_add_f32 v172, v172, v173
  v_mul_f32 v172, 0x3b000000, v172
  v_cvt_pk_bf16_f32 v174, v172, v172
  v_lshlrev_b32 v174, 16, v174
  v_sub_f32 v173, v172, v174
  v_sub_f32 v156, v156, v174
  v_sub_f32 v157, v157, v174
  v_sub_f32 v158, v158, v174
  v_sub_f32 v159, v159, v174
  v_sub_f32 v160, v160, v174
  v_sub_f32 v161, v161, v174
  v_sub_f32 v162, v162, v174
  v_sub_f32 v163, v163, v174
  v_sub_f32 v164, v164, v174
  v_sub_f32 v165, v165, v174
  v_sub_f32 v166, v166, v174
  v_sub_f32 v167, v167, v174
  v_sub_f32 v168, v168, v174
  v_sub_f32 v169, v169, v174
  v_sub_f32 v170, v170, v174
  v_sub_f32 v171, v171, v174
  v_mul_f32 v176, v156, v156
  v_mul_f32 v177, v157, v157
  v_fmac_f32 v176, v158, v158
  v_fmac_f32 v177, v159, v159
  v_fmac_f32 v176, v160, v160
  v_fmac_f32 v177, v161, v161
  v_fmac_f32 v176, v162, v162
  v_fmac_f32 v177, v163, v163
  v_fmac_f32 v176, v164, v164
  v_fmac_f32 v177, v165, v165
  v_fmac_f32 v176, v166, v166
  v_fmac_f32 v177, v167, v167
  v_fmac_f32 v176, v168, v168
  v_fmac_f32 v177, v169, v169
  v_fmac_f32 v176, v170, v170
  v_fmac_f32 v177, v171, v171
  v_add_f32 v176, v176, v177
  s_nop 1
  v_add_f32_dpp v176, v176, v176 quad_perm:[1,0,3,2] row_mask:0xf bank_mask:0xf
  s_nop 1
  v_add_f32_dpp v176, v176, v176 quad_perm:[2,3,0,1] row_mask:0xf bank_mask:0xf
  s_nop 1
  v_add_f32_dpp v176, v176, v176 row_half_mirror row_mask:0xf bank_mask:0xf
  s_nop 1
  v_add_f32_dpp v176, v176, v176 row_mirror row_mask:0xf bank_mask:0xf
  v_mov_b32 v177, v176
  s_nop 1
  v_permlane16_swap_b32 v176, v177
  v_add_f32 v176, v176, v177
  v_mul_f32 v176, 0x3b000000, v176
  v_fma_f32 v176, -v173, v173, v176
  v_max_f32 v176, 0, v176
  v_cvt_pk_bf16_f32 v176, v176, v176
  v_lshlrev_b32 v176, 16, v176
  v_add_f32 v176, 0x3727c5ac, v176
  v_cvt_pk_bf16_f32 v176, v176, v176
  v_lshlrev_b32 v176, 16, v176
  v_sqrt_f32 v176, v176
  s_nop 0
  v_cvt_pk_bf16_f32 v136, v172, v176
  s_waitcnt lgkmcnt(0)
  s_cmp_eq_u32 s10, 0
  s_cbranch_scc1 slow_1
back_2:
  v_mov_b32 v137, s10
  s_mov_b32 exec_lo, 1
  s_mov_b32 exec_hi, 1
  global_store_dwordx2 v139, v[136:137], s[48:49] sc1
  s_mov_b64 exec, -1
  s_barrier
  ds_read_b64_tr_b16 v[24:25], v56 offset:0
  ds_read_b64_tr_b16 v[26:27], v56 offset:1024
  ds_read_b128 v[16:19], v48 offset:0
  ds_read_b128 v[20:23], v48 offset:4096
  ds_read_b64_tr_b16 v[28:29], v57 offset:0
  ds_read_b64_tr_b16 v[30:31], v57 offset:1024
  ds_read_b64_tr_b16 v[40:41], v56 offset:4096
  ds_read_b64_tr_b16 v[42:43], v56 offset:5120
  ds_read_b128 v[32:35], v49 offset:0
  ds_read_b128 v[36:39], v49 offset:4096
  ds_read_b64_tr_b16 v[44:45], v57 offset:4096
  ds_read_b64_tr_b16 v[46:47], v57 offset:5120
  s_waitcnt lgkmcnt(10)
  v_mfma_f32_16x16x32_bf16 v[12:15], v[8:11], v[24:27], 0
  ds_read_b64_tr_b16 v[72:73], v56 offset:8192
  ds_read_b64_tr_b16 v[74:75], v56 offset:9216
  s_waitcnt lgkmcnt(11)
  v_mfma_f32_32x32x16_bf16 v[192:207], v[24:27], v[16:19], 0
  ds_read_b128 v[64:67], v50 offset:0
  s_waitcnt lgkmcnt(11)
  v_mfma_f32_32x32x16_bf16 v[208:223], v[24:27], v[20:23], 0
  ds_read_b128 v[68:71], v50 offset:4096
  s_waitcnt lgkmcnt(10)
  v_mfma_f32_32x32x16_bf16 v[224:239], v[28:31], v[16:19], 0
  ds_read_b64_tr_b16 v[76:77], v57 offset:8192
  ds_read_b64_tr_b16 v[78:79], v57 offset:9216
  v_mfma_f32_32x32x16_bf16 v[240:255], v[28:31], v[20:23], 0
  s_load_dword s10, s[92:93], 128
  s_waitcnt lgkmcnt(10)
  v_mfma_f32_16x16x32_bf16 v[12:15], v[8:11], v[40:43], v[12:15]
  ds_read_b64_tr_b16 v[24:25], v56 offset:12288
  ds_read_b64_tr_b16 v[26:27], v56 offset:13312
  s_waitcnt lgkmcnt(11)
  v_mfma_f32_32x32x16_bf16 v[192:207], v[40:43], v[32:35], v[192:207]
  ds_read_b128 v[16:19], v51 offset:0
  s_waitcnt lgkmcnt(11)
  v_mfma_f32_32x32x16_bf16 v[208:223], v[40:43], v[36:39], v[208:223]
  ds_read_b128 v[20:23], v51 offset:4096
  s_waitcnt lgkmcnt(10)
  v_mfma_f32_32x32x16_bf16 v[224:239], v[44:47], v[32:35], v[224:239]
  ds_read_b64_tr_b16 v[28:29], v57 offset:12288
  ds_read_b64_tr_b16 v[30:31], v57 offset:13312
  v_mfma_f32_32x32x16_bf16 v[240:255], v[44:47], v[36:39], v[240:255]
  s_waitcnt lgkmcnt(10)
  v_mfma_f32_16x16x32_bf16 v[12:15], v[8:11], v[72:75], v[12:15]
  s_barrier
  ds_read_b64_tr_b16 v[40:41], v56 offset:32768
  ds_read_b64_tr_b16 v[42:43], v56 offset:33792
  s_waitcnt lgkmcnt(11)
  v_mfma_f32_32x32x16_bf16 v[192:207], v[72:75], v[64:67], v[192:207]
  ds_read_b128 v[32:35], v48 offset:32768
  s_waitcnt lgkmcnt(11)
  v_mfma_f32_32x32x16_bf16 v[208:223], v[72:75], v[68:71], v[208:223]
  ds_read_b128 v[36:39], v48 offset:36864
  s_waitcnt lgkmcnt(10)
  v_mfma_f32_32x32x16_bf16 v[224:239], v[76:79], v[64:67], v[224:239]
  ds_read_b64_tr_b16 v[44:45], v57 offset:32768
  ds_read_b64_tr_b16 v[46:47], v57 offset:33792
  v_mfma_f32_32x32x16_bf16 v[240:255], v[76:79], v[68:71], v[240:255]
  s_waitcnt vmcnt(1)
  s_lshl_b32 s11, s100, 10
  s_add_u32 s11, s11, 131072
  v_add_u32 v116, s11, v117
  ds_read_b64_tr_b16 v[180:181], v116 offset:0
  ds_read_b64_tr_b16 v[182:183], v116 offset:512
  s_lshl_b32 s11, s101, 10
  s_add_u32 s11, s11, 131072
  v_add_u32 v116, s11, v117
  ds_read_b64_tr_b16 v[184:185], v116 offset:0
  ds_read_b64_tr_b16 v[186:187], v116 offset:512
  s_waitcnt lgkmcnt(0)
  s_mul_i32 s11, s50, 112
  s_add_u32 s11, s11, s51
  s_add_u32 s11, s11, s100
  s_lshl_b32 s11, s11, 10
  s_add_u32 s11, s11, 8388608
  buffer_store_dwordx4 v[180:183], v146, s[64:67], s11 offen sc1
  s_mul_i32 s11, s50, 112
  s_add_u32 s11, s11, s51
  s_add_u32 s11, s11, s101
  s_lshl_b32 s11, s11, 10
  s_add_u32 s11, s11, 8388608
  buffer_store_dwordx4 v[184:187], v146, s[64:67], s11 offen sc1
  s_waitcnt lgkmcnt(0)
  s_cmp_eq_u32 s10, 0
  s_cbranch_scc1 slow_3
back_4:
  v_mfma_f32_16x16x32_bf16 v[12:15], v[8:11], v[24:27], v[12:15]
  ds_read_b64_tr_b16 v[72:73], v56 offset:36864
  ds_read_b64_tr_b16 v[74:75], v56 offset:37888
  v_mfma_f32_32x32x16_bf16 v[192:207], v[24:27], v[16:19], v[192:207]
  ds_read_b128 v[64:67], v49 offset:32768
  v_mfma_f32_32x32x16_bf16 v[208:223], v[24:27], v[20:23], v[208:223]
  ds_read_b128 v[68:71], v49 offset:36864
  v_mfma_f32_32x32x16_bf16 v[224:239], v[28:31], v[16:19], v[224:239]
  ds_read_b64_tr_b16 v[76:77], v57 offset:36864
  ds_read_b64_tr_b16 v[78:79], v57 offset:37888
  v_mfma_f32_32x32x16_bf16 v[240:255], v[28:31], v[20:23], v[240:255]
  v_mfma_f32_16x16x32_bf16 v[12:15], v[8:11], v[40:43], v[12:15]
  ds_read_b64_tr_b16 v[24:25], v56 offset:40960
  ds_read_b64_tr_b16 v[26:27], v56 offset:41984
  v_mfma_f32_32x32x16_bf16 v[192:207], v[40:43], v[32:35], v[192:207]
  ds_read_b128 v[16:19], v50 offset:32768
  v_mfma_f32_32x32x16_bf16 v[208:223], v[40:43], v[36:39], v[208:223]
  ds_read_b128 v[20:23], v50 offset:36864
  v_mfma_f32_32x32x16_bf16 v[224:239], v[44:47], v[32:35], v[224:239]
  ds_read_b64_tr_b16 v[28:29], v57 offset:40960
  ds_read_b64_tr_b16 v[30:31], v57 offset:41984
  v_mfma_f32_32x32x16_bf16 v[240:255], v[44:47], v[36:39], v[240:255]
  s_waitcnt lgkmcnt(10)
  v_mfma_f32_16x16x32_bf16 v[12:15], v[8:11], v[72:75], v[12:15]
  ds_read_b64_tr_b16 v[40:41], v56 offset:45056
  ds_read_b64_tr_b16 v[42:43], v56 offset:46080
  s_waitcnt lgkmcnt(11)
  v_mfma_f32_32x32x16_bf16 v[192:207], v[72:75], v[64:67], v[192:207]
  ds_read_b128 v[32:35], v51 offset:32768
  s_waitcnt lgkmcnt(11)
  v_mfma_f32_32x32x16_bf16 v[208:223], v[72:75], v[68:71], v[208:223]
  ds_read_b128 v[36:39], v51 offset:36864
  s_waitcnt lgkmcnt(10)
  v_mfma_f32_32x32x16_bf16 v[224:239], v[76:79], v[64:67], v[224:239]
  ds_read_b64_tr_b16 v[44:45], v57 offset:45056
  ds_read_b64_tr_b16 v[46:47], v57 offset:46080
  v_mfma_f32_32x32x16_bf16 v[240:255], v[76:79], v[68:71], v[240:255]
  s_waitcnt lgkmcnt(10)
  v_mfma_f32_16x16x32_bf16 v[12:15], v[8:11], v[24:27], v[12:15]
  s_barrier
  ds_read_b64_tr_b16 v[72:73], v58 offset:0
  ds_read_b64_tr_b16 v[74:75], v58 offset:1024
  s_waitcnt lgkmcnt(11)
  v_mfma_f32_32x32x16_bf16 v[192:207], v[24:27], v[16:19], v[192:207]
  ds_read_b128 v[64:67], v52 offset:0
  s_waitcnt lgkmcnt(11)
  v_mfma_f32_32x32x16_bf16 v[208:223], v[24:27], v[20:23], v[208:223]
  ds_read_b128 v[68:71], v52 offset:4096
  s_waitcnt lgkmcnt(10)
  v_mfma_f32_32x32x16_bf16 v[224:239], v[28:31], v[16:19], v[224:239]
  ds_read_b64_tr_b16 v[76:77], v59 offset:0
  ds_read_b64_tr_b16 v[78:79], v59 offset:1024
  v_mfma_f32_32x32x16_bf16 v[240:255], v[28:31], v[20:23], v[240:255]
  s_lshl_b32 s94, s4, 2
  s_lshr_b32 s11, s5, 3
  s_add_u32 s94, s94, s11
  s_add_u32 s94, s94, 137
  s_waitcnt vmcnt(0)
  s_lshl_b32 s11, s94, 7
  s_add_u32 s11, s11, 15269888
  v_mov_b32 v180, s11
  v_mov_b32 v181, 1
  s_mov_b64 exec, 1
  global_atomic_add v181, v180, v181, s[48:49] sc0 sc1
  s_mov_b64 exec, -1
  s_waitcnt lgkmcnt(10)
  v_mfma_f32_16x16x32_bf16 v[12:15], v[8:11], v[40:43], v[12:15]
  ds_read_b64_tr_b16 v[24:25], v58 offset:4096
  ds_read_b64_tr_b16 v[26:27], v58 offset:5120
  s_waitcnt lgkmcnt(11)
  v_mfma_f32_32x32x16_bf16 v[192:207], v[40:43], v[32:35], v[192:207]
  ds_read_b128 v[16:19], v53 offset:0
  s_waitcnt lgkmcnt(11)
  v_mfma_f32_32x32x16_bf16 v[208:223], v[40:43], v[36:39], v[208:223]
  ds_read_b128 v[20:23], v53 offset:4096
  s_waitcnt lgkmcnt(10)
  v_mfma_f32_32x32x16_bf16 v[224:239], v[44:47], v[32:35], v[224:239]
  ds_read_b64_tr_b16 v[28:29], v59 offset:4096
  ds_read_b64_tr_b16 v[30:31], v59 offset:5120
  v_mfma_f32_32x32x16_bf16 v[240:255], v[44:47], v[36:39], v[240:255]
  s_waitcnt lgkmcnt(10)
  v_mfma_f32_16x16x32_bf16 v[12:15], v[8:11], v[72:75], v[12:15]
  ds_read_b64_tr_b16 v[40:41], v58 offset:8192
  ds_read_b64_tr_b16 v[42:43], v58 offset:9216
  s_waitcnt lgkmcnt(11)
  v_mfma_f32_32x32x16_bf16 v[192:207], v[72:75], v[64:67], v[192:207]
  ds_read_b128 v[32:35], v54 offset:0
  s_waitcnt lgkmcnt(11)
  v_mfma_f32_32x32x16_bf16 v[208:223], v[72:75], v[68:71], v[208:223]
  ds_read_b128 v[36:39], v54 offset:4096
  s_waitcnt lgkmcnt(10)
  v_mfma_f32_32x32x16_bf16 v[224:239], v[76:79], v[64:67], v[224:239]
  ds_read_b64_tr_b16 v[44:45], v59 offset:8192
  ds_read_b64_tr_b16 v[46:47], v59 offset:9216
  v_mfma_f32_32x32x16_bf16 v[240:255], v[76:79], v[68:71], v[240:255]
  s_waitcnt lgkmcnt(10)
  v_mfma_f32_16x16x32_bf16 v[12:15], v[8:11], v[24:27], v[12:15]
  ds_read_b64_tr_b16 v[72:73], v58 offset:12288
  ds_read_b64_tr_b16 v[74:75], v58 offset:13312
  s_waitcnt lgkmcnt(11)
  v_mfma_f32_32x32x16_bf16 v[192:207], v[24:27], v[16:19], v[192:207]
  ds_read_b128 v[64:67], v55 offset:0
  s_waitcnt lgkmcnt(11)
  v_mfma_f32_32x32x16_bf16 v[208:223], v[24:27], v[20:23], v[208:223]
  ds_read_b128 v[68:71], v55 offset:4096
  s_waitcnt lgkmcnt(10)
  v_mfma_f32_32x32x16_bf16 v[224:239], v[28:31], v[16:19], v[224:239]
  ds_read_b64_tr_b16 v[76:77], v59 offset:12288
  ds_read_b64_tr_b16 v[78:79], v59 offset:13312
  v_mfma_f32_32x32x16_bf16 v[240:255], v[28:31], v[20:23], v[240:255]
  s_waitcnt lgkmcnt(10)
  v_mfma_f32_16x16x32_bf16 v[12:15], v[8:11], v[40:43], v[12:15]
  s_barrier
  ds_read_b64_tr_b16 v[24:25], v58 offset:32768
  ds_read_b64_tr_b16 v[26:27], v58 offset:33792
  s_waitcnt lgkmcnt(11)
  v_mfma_f32_32x32x16_bf16 v[192:207], v[40:43], v[32:35], v[192:207]
  ds_read_b128 v[16:19], v52 offset:32768
  s_waitcnt lgkmcnt(11)
  v_mfma_f32_32x32x16_bf16 v[208:223], v[40:43], v[36:39], v[208:223]
  ds_read_b128 v[20:23], v52 offset:36864
  s_waitcnt lgkmcnt(10)
  v_mfma_f32_32x32x16_bf16 v[224:239], v[44:47], v[32:35], v[224:239]
  ds_read_b64_tr_b16 v[28:29], v59 offset:32768
  ds_read_b64_tr_b16 v[30:31], v59 offset:33792
  v_mfma_f32_32x32x16_bf16 v[240:255], v[44:47], v[36:39], v[240:255]
  s_waitcnt lgkmcnt(10)
  v_mfma_f32_16x16x32_bf16 v[12:15], v[8:11], v[72:75], v[12:15]
  ds_read_b64_tr_b16 v[40:41], v58 offset:36864
  ds_read_b64_tr_b16 v[42:43], v58 offset:37888
  s_waitcnt lgkmcnt(11)
  v_mfma_f32_32x32x16_bf16 v[192:207], v[72:75], v[64:67], v[192:207]
  ds_read_b128 v[32:35], v53 offset:32768
  s_waitcnt lgkmcnt(11)
  v_mfma_f32_32x32x16_bf16 v[208:223], v[72:75], v[68:71], v[208:223]
  ds_read_b128 v[36:39], v53 offset:36864
  s_waitcnt lgkmcnt(10)
  v_mfma_f32_32x32x16_bf16 v[224:239], v[76:79], v[64:67], v[224:239]
  ds_read_b64_tr_b16 v[44:45], v59 offset:36864
  ds_read_b64_tr_b16 v[46:47], v59 offset:37888
  v_mfma_f32_32x32x16_bf16 v[240:255], v[76:79], v[68:71], v[240:255]
  s_waitcnt lgkmcnt(10)
  v_mfma_f32_16x16x32_bf16 v[12:15], v[8:11], v[24:27], v[12:15]
  ds_read_b64_tr_b16 v[72:73], v58 offset:40960
  ds_read_b64_tr_b16 v[74:75], v58 offset:41984
  s_waitcnt lgkmcnt(11)
  v_mfma_f32_32x32x16_bf16 v[192:207], v[24:27], v[16:19], v[192:207]
  ds_read_b128 v[64:67], v54 offset:32768
  s_waitcnt lgkmcnt(11)
  v_mfma_f32_32x32x16_bf16 v[208:223], v[24:27], v[20:23], v[208:223]
  ds_read_b128 v[68:71], v54 offset:36864
  s_waitcnt lgkmcnt(10)
  v_mfma_f32_32x32x16_bf16 v[224:239], v[28:31], v[16:19], v[224:239]
  ds_read_b64_tr_b16 v[76:77], v59 offset:40960
  ds_read_b64_tr_b16 v[78:79], v59 offset:41984
  v_mfma_f32_32x32x16_bf16 v[240:255], v[28:31], v[20:23], v[240:255]
  s_waitcnt lgkmcnt(10)
  v_mfma_f32_16x16x32_bf16 v[12:15], v[8:11], v[40:43], v[12:15]
  ds_read_b64_tr_b16 v[24:25], v58 offset:45056
  ds_read_b64_tr_b16 v[26:27], v58 offset:46080
  s_waitcnt lgkmcnt(11)
  v_mfma_f32_32x32x16_bf16 v[192:207], v[40:43], v[32:35], v[192:207]
  ds_read_b128 v[16:19], v55 offset:32768
  s_waitcnt lgkmcnt(11)
  v_mfma_f32_32x32x16_bf16 v[208:223], v[40:43], v[36:39], v[208:223]
  ds_read_b128 v[20:23], v55 offset:36864
  s_waitcnt lgkmcnt(10)
  v_mfma_f32_32x32x16_bf16 v[224:239], v[44:47], v[32:35], v[224:239]
  ds_read_b64_tr_b16 v[28:29], v59 offset:45056
  ds_read_b64_tr_b16 v[30:31], v59 offset:46080
  v_mfma_f32_32x32x16_bf16 v[240:255], v[44:47], v[36:39], v[240:255]
  s_waitcnt vmcnt(0)
  v_readfirstlane_b32 s12, v181
  s_nop 0
  s_cmp_eq_u32 s12, 31
  s_cbranch_scc1 cond_5
back_6:
  s_waitcnt lgkmcnt(10)
  v_mfma_f32_16x16x32_bf16 v[12:15], v[8:11], v[72:75], v[12:15]
  s_barrier
  ds_read_b64_tr_b16 v[40:41], v56 offset:0
  ds_read_b64_tr_b16 v[42:43], v56 offset:1024
  s_waitcnt lgkmcnt(11)
  v_mfma_f32_32x32x16_bf16 v[192:207], v[72:75], v[64:67], v[192:207]
  ds_read_b128 v[32:35], v48 offset:0
  s_waitcnt lgkmcnt(11)
  v_mfma_f32_32x32x16_bf16 v[208:223], v[72:75], v[68:71], v[208:223]
  ds_read_b128 v[36:39], v48 offset:4096
  s_waitcnt lgkmcnt(10)
  v_mfma_f32_32x32x16_bf16 v[224:239], v[76:79], v[64:67], v[224:239]
  ds_read_b64_tr_b16 v[44:45], v57 offset:0
  ds_read_b64_tr_b16 v[46:47], v57 offset:1024
  v_mfma_f32_32x32x16_bf16 v[240:255], v[76:79], v[68:71], v[240:255]
  s_waitcnt lgkmcnt(10)
  v_mfma_f32_16x16x32_bf16 v[12:15], v[8:11], v[24:27], v[12:15]
  ds_read_b64_tr_b16 v[72:73], v56 offset:4096
  ds_read_b64_tr_b16 v[74:75], v56 offset:5120
  s_waitcnt lgkmcnt(11)
  v_mfma_f32_32x32x16_bf16 v[192:207], v[24:27], v[16:19], v[192:207]
  ds_read_b128 v[64:67], v49 offset:0
  s_waitcnt lgkmcnt(11)
  v_mfma_f32_32x32x16_bf16 v[208:223], v[24:27], v[20:23], v[208:223]
  ds_read_b128 v[68:71], v49 offset:4096
  s_waitcnt lgkmcnt(10)
  v_mfma_f32_32x32x16_bf16 v[224:239], v[28:31], v[16:19], v[224:239]
  ds_read_b64_tr_b16 v[76:77], v57 offset:4096
  ds_read_b64_tr_b16 v[78:79], v57 offset:5120
  v_mfma_f32_32x32x16_bf16 v[240:255], v[28:31], v[20:23], v[240:255]
  s_waitcnt lgkmcnt(10)
  v_mfma_f32_16x16x32_bf16 v[12:15], v[8:11], v[40:43], v[12:15]
  ds_read_b64_tr_b16 v[24:25], v56 offset:8192
  ds_read_b64_tr_b16 v[26:27], v56 offset:9216
  s_waitcnt lgkmcnt(11)
  v_mfma_f32_32x32x16_bf16 v[192:207], v[40:43], v[32:35], v[192:207]
  ds_read_b128 v[16:19], v50 offset:0
  s_waitcnt lgkmcnt(11)
  v_mfma_f32_32x32x16_bf16 v[208:223], v[40:43], v[36:39], v[208:223]
  ds_read_b128 v[20:23], v50 offset:4096
  s_waitcnt lgkmcnt(10)
  v_mfma_f32_32x32x16_bf16 v[224:239], v[44:47], v[32:35], v[224:239]
  ds_read_b64_tr_b16 v[28:29], v57 offset:8192
  ds_read_b64_tr_b16 v[30:31], v57 offset:9216
  v_mfma_f32_32x32x16_bf16 v[240:255], v[44:47], v[36:39], v[240:255]
  s_waitcnt lgkmcnt(10)
  v_mfma_f32_16x16x32_bf16 v[12:15], v[8:11], v[72:75], v[12:15]
  ds_read_b64_tr_b16 v[40:41], v56 offset:12288
  ds_read_b64_tr_b16 v[42:43], v56 offset:13312
  s_waitcnt lgkmcnt(11)
  v_mfma_f32_32x32x16_bf16 v[192:207], v[72:75], v[64:67], v[192:207]
  ds_read_b128 v[32:35], v51 offset:0
  s_waitcnt lgkmcnt(11)
  v_mfma_f32_32x32x16_bf16 v[208:223], v[72:75], v[68:71], v[208:223]
  ds_read_b128 v[36:39], v51 offset:4096
  s_waitcnt lgkmcnt(10)
  v_mfma_f32_32x32x16_bf16 v[224:239], v[76:79], v[64:67], v[224:239]
  ds_read_b64_tr_b16 v[44:45], v57 offset:12288
  ds_read_b64_tr_b16 v[46:47], v57 offset:13312
  v_mfma_f32_32x32x16_bf16 v[240:255], v[76:79], v[68:71], v[240:255]
  s_waitcnt lgkmcnt(10)
  v_mfma_f32_16x16x32_bf16 v[12:15], v[8:11], v[24:27], v[12:15]
  s_barrier
  ds_read_b64_tr_b16 v[72:73], v56 offset:32768
  ds_read_b64_tr_b16 v[74:75], v56 offset:33792
  s_waitcnt lgkmcnt(11)
  v_mfma_f32_32x32x16_bf16 v[192:207], v[24:27], v[16:19], v[192:207]
  ds_read_b128 v[64:67], v48 offset:32768
  s_waitcnt lgkmcnt(11)
  v_mfma_f32_32x32x16_bf16 v[208:223], v[24:27], v[20:23], v[208:223]
  ds_read_b128 v[68:71], v48 offset:36864
  s_waitcnt lgkmcnt(10)
  v_mfma_f32_32x32x16_bf16 v[224:239], v[28:31], v[16:19], v[224:239]
  ds_read_b64_tr_b16 v[76:77], v57 offset:32768
  ds_read_b64_tr_b16 v[78:79], v57 offset:33792
  v_mfma_f32_32x32x16_bf16 v[240:255], v[28:31], v[20:23], v[240:255]
  s_waitcnt lgkmcnt(10)
  v_mfma_f32_16x16x32_bf16 v[12:15], v[8:11], v[40:43], v[12:15]
  ds_read_b64_tr_b16 v[24:25], v56 offset:36864
  ds_read_b64_tr_b16 v[26:27], v56 offset:37888
  s_waitcnt lgkmcnt(11)
  v_mfma_f32_32x32x16_bf16 v[192:207], v[40:43], v[32:35], v[192:207]
  ds_read_b128 v[16:19], v49 offset:32768
  s_waitcnt lgkmcnt(11)
  v_mfma_f32_32x32x16_bf16 v[208:223], v[40:43], v[36:39], v[208:223]
  ds_read_b128 v[20:23], v49 offset:36864
  s_waitcnt lgkmcnt(10)
  v_mfma_f32_32x32x16_bf16 v[224:239], v[44:47], v[32:35], v[224:239]
  ds_read_b64_tr_b16 v[28:29], v57 offset:36864
  ds_read_b64_tr_b16 v[30:31], v57 offset:37888
  v_mfma_f32_32x32x16_bf16 v[240:255], v[44:47], v[36:39], v[240:255]
  s_waitcnt lgkmcnt(10)
  v_mfma_f32_16x16x32_bf16 v[12:15], v[8:11], v[72:75], v[12:15]
  ds_read_b64_tr_b16 v[40:41], v56 offset:40960
  ds_read_b64_tr_b16 v[42:43], v56 offset:41984
  s_waitcnt lgkmcnt(11)
  v_mfma_f32_32x32x16_bf16 v[192:207], v[72:75], v[64:67], v[192:207]
  ds_read_b128 v[32:35], v50 offset:32768
  s_waitcnt lgkmcnt(11)
  v_mfma_f32_32x32x16_bf16 v[208:223], v[72:75], v[68:71], v[208:223]
  ds_read_b128 v[36:39], v50 offset:36864
  s_waitcnt lgkmcnt(10)
  v_mfma_f32_32x32x16_bf16 v[224:239], v[76:79], v[64:67], v[224:239]
  ds_read_b64_tr_b16 v[44:45], v57 offset:40960
  ds_read_b64_tr_b16 v[46:47], v57 offset:41984
  v_mfma_f32_32x32x16_bf16 v[240:255], v[76:79], v[68:71], v[240:255]
  s_mul_i32 s11, s9, 229376
  s_mul_i32 s12, s3, 28672
  s_add_u32 s11, s11, s12
  s_add_u32 s50, s11, 8388608
  s_mul_i32 s11, s8, 229376
  s_add_u32 s51, s11, s12
  s_lshr_b32 s11, s3, 1
  s_mul_i32 s11, s11, 114688
  s_sub_u32 s12, 114688, s11
  s_add_u32 s52, s50, s12
  s_add_u32 s50, s50, s11
  s_and_b32 s11, s3, 1
  s_mul_i32 s11, s11, 114688
  s_sub_u32 s12, 114688, s11
  s_add_u32 s53, s51, s12
  s_add_u32 s51, s51, s11
  s_waitcnt lgkmcnt(10)
  v_mfma_f32_16x16x32_bf16 v[12:15], v[8:11], v[24:27], v[12:15]
  ds_read_b64_tr_b16 v[72:73], v56 offset:45056
  ds_read_b64_tr_b16 v[74:75], v56 offset:46080
  s_waitcnt lgkmcnt(11)
  v_mfma_f32_32x32x16_bf16 v[192:207], v[24:27], v[16:19], v[192:207]
  ds_read_b128 v[64:67], v51 offset:32768
  s_waitcnt lgkmcnt(11)
  v_mfma_f32_32x32x16_bf16 v[208:223], v[24:27], v[20:23], v[208:223]
  ds_read_b128 v[68:71], v51 offset:36864
  s_waitcnt lgkmcnt(10)
  v_mfma_f32_32x32x16_bf16 v[224:239], v[28:31], v[16:19], v[224:239]
  ds_read_b64_tr_b16 v[76:77], v57 offset:45056
  ds_read_b64_tr_b16 v[78:79], v57 offset:46080
  v_mfma_f32_32x32x16_bf16 v[240:255], v[28:31], v[20:23], v[240:255]
  s_lshl_b32 s11, s68, 8
  s_lshl_b32 s12, s69, 7
  s_add_u32 s11, s11, s12
  s_add_u32 s13, s11, 162368
  v_lshlrev_b32 v1, 2, v0
  v_add_u32 v1, s13, v1
  v_mov_b32 v4, 163396
  v_mov_b32 v5, 10
  v_lshrrev_b32 v61, 5, v0
  v_lshlrev_b32 v61, 4, v61
  v_add_u32 v61, s13, v61
  v_xor_b32 v62, 128, v61
  s_waitcnt lgkmcnt(10)
  v_mfma_f32_16x16x32_bf16 v[12:15], v[8:11], v[40:43], v[12:15]
  s_barrier
  ds_read_b64_tr_b16 v[24:25], v58 offset:0
  ds_read_b64_tr_b16 v[26:27], v58 offset:1024
  s_waitcnt lgkmcnt(11)
  v_mfma_f32_32x32x16_bf16 v[192:207], v[40:43], v[32:35], v[192:207]
  ds_read_b128 v[16:19], v52 offset:0
  s_waitcnt lgkmcnt(11)
  v_mfma_f32_32x32x16_bf16 v[208:223], v[40:43], v[36:39], v[208:223]
  ds_read_b128 v[20:23], v52 offset:4096
  s_waitcnt lgkmcnt(10)
  v_mfma_f32_32x32x16_bf16 v[224:239], v[44:47], v[32:35], v[224:239]
  ds_read_b64_tr_b16 v[28:29], v59 offset:0
  ds_read_b64_tr_b16 v[30:31], v59 offset:1024
  v_mfma_f32_32x32x16_bf16 v[240:255], v[44:47], v[36:39], v[240:255]
  s_waitcnt lgkmcnt(10)
  v_mfma_f32_16x16x32_bf16 v[12:15], v[8:11], v[72:75], v[12:15]
  ds_read_b64_tr_b16 v[40:41], v58 offset:4096
  ds_read_b64_tr_b16 v[42:43], v58 offset:5120
  s_waitcnt lgkmcnt(11)
  v_mfma_f32_32x32x16_bf16 v[192:207], v[72:75], v[64:67], v[192:207]
  ds_read_b128 v[32:35], v53 offset:0
  s_waitcnt lgkmcnt(11)
  v_mfma_f32_32x32x16_bf16 v[208:223], v[72:75], v[68:71], v[208:223]
  ds_read_b128 v[36:39], v53 offset:4096
  s_waitcnt lgkmcnt(10)
  v_mfma_f32_32x32x16_bf16 v[224:239], v[76:79], v[64:67], v[224:239]
  ds_read_b64_tr_b16 v[44:45], v59 offset:4096
  ds_read_b64_tr_b16 v[46:47], v59 offset:5120
  v_mfma_f32_32x32x16_bf16 v[240:255], v[76:79], v[68:71], v[240:255]
  v_and_b32 v2, 31, v0
  s_lshl_b32 s11, s69, 6
  v_add_u32 v2, s11, v2
  v_lshlrev_b32 v2, 3, v2
  v_add_u32 v2, 161344, v2
  s_mov_b32 s14, 0xbdd2d3e8
  s_mov_b32 s15, 0xbdd2d3e8
  v_mov_b32 v164, 0xc0135761
  v_mov_b32 v165, 0xc0135761
  v_mov_b32 v166, 1.0
  v_mov_b32 v167, 1.0
  s_waitcnt lgkmcnt(10)
  v_mfma_f32_16x16x32_bf16 v[12:15], v[8:11], v[24:27], v[12:15]
  ds_read_b64_tr_b16 v[72:73], v58 offset:8192
  ds_read_b64_tr_b16 v[74:75], v58 offset:9216
  s_waitcnt lgkmcnt(11)
  v_mfma_f32_32x32x16_bf16 v[192:207], v[24:27], v[16:19], v[192:207]
  ds_read_b128 v[64:67], v54 offset:0
  s_waitcnt lgkmcnt(11)
  v_mfma_f32_32x32x16_bf16 v[208:223], v[24:27], v[20:23], v[208:223]
  ds_read_b128 v[68:71], v54 offset:4096
  s_waitcnt lgkmcnt(10)
  v_mfma_f32_32x32x16_bf16 v[224:239], v[28:31], v[16:19], v[224:239]
  ds_read_b64_tr_b16 v[76:77], v59 offset:8192
  ds_read_b64_tr_b16 v[78:79], v59 offset:9216
  v_mfma_f32_32x32x16_bf16 v[240:255], v[28:31], v[20:23], v[240:255]
  s_lshl_b32 s11, s6, 2
  s_lshl_b32 s12, s69, 1
  s_add_u32 s11, s11, s12
  s_mul_i32 s11, s11, 114688
  s_lshl_b32 s12, s7, 13
  s_add_u32 s11, s11, s12
  s_lshl_b32 s12, s68, 12
  s_add_u32 s11, s11, s12
  s_lshl_b32 s12, s69, 11
  s_add_u32 s98, s11, s12
  s_xor_b32 s99, s98, 2048
  s_waitcnt lgkmcnt(10)
  v_mfma_f32_16x16x32_bf16 v[12:15], v[8:11], v[40:43], v[12:15]
  ds_read_b64_tr_b16 v[24:25], v58 offset:12288
  ds_read_b64_tr_b16 v[26:27], v58 offset:13312
  s_waitcnt lgkmcnt(11)
  v_mfma_f32_32x32x16_bf16 v[192:207], v[40:43], v[32:35], v[192:207]
  ds_read_b128 v[16:19], v55 offset:0
  s_waitcnt lgkmcnt(11)
  v_mfma_f32_32x32x16_bf16 v[208:223], v[40:43], v[36:39], v[208:223]
  ds_read_b128 v[20:23], v55 offset:4096
  s_waitcnt lgkmcnt(10)
  v_mfma_f32_32x32x16_bf16 v[224:239], v[44:47], v[32:35], v[224:239]
  ds_read_b64_tr_b16 v[28:29], v59 offset:12288
  ds_read_b64_tr_b16 v[30:31], v59 offset:13312
  v_mfma_f32_32x32x16_bf16 v[240:255], v[44:47], v[36:39], v[240:255]
  s_waitcnt lgkmcnt(10)
  v_mfma_f32_16x16x32_bf16 v[12:15], v[8:11], v[72:75], v[12:15]
  s_barrier
  ds_read_b64_tr_b16 v[40:41], v58 offset:32768
  ds_read_b64_tr_b16 v[42:43], v58 offset:33792
  s_waitcnt lgkmcnt(11)
  v_mfma_f32_32x32x16_bf16 v[192:207], v[72:75], v[64:67], v[192:207]
  ds_read_b128 v[32:35], v52 offset:32768
  s_waitcnt lgkmcnt(11)
  v_mfma_f32_32x32x16_bf16 v[208:223], v[72:75], v[68:71], v[208:223]
  ds_read_b128 v[36:39], v52 offset:36864
  s_waitcnt lgkmcnt(10)
  v_mfma_f32_32x32x16_bf16 v[224:239], v[76:79], v[64:67], v[224:239]
  ds_read_b64_tr_b16 v[44:45], v59 offset:32768
  ds_read_b64_tr_b16 v[46:47], v59 offset:33792
  v_mfma_f32_32x32x16_bf16 v[240:255], v[76:79], v[68:71], v[240:255]
  s_waitcnt lgkmcnt(10)
  v_mfma_f32_16x16x32_bf16 v[12:15], v[8:11], v[24:27], v[12:15]
  ds_read_b64_tr_b16 v[72:73], v58 offset:36864
  ds_read_b64_tr_b16 v[74:75], v58 offset:37888
  s_waitcnt lgkmcnt(11)
  v_mfma_f32_32x32x16_bf16 v[192:207], v[24:27], v[16:19], v[192:207]
  ds_read_b128 v[64:67], v53 offset:32768
  s_waitcnt lgkmcnt(11)
  v_mfma_f32_32x32x16_bf16 v[208:223], v[24:27], v[20:23], v[208:223]
  ds_read_b128 v[68:71], v53 offset:36864
  s_waitcnt lgkmcnt(10)
  v_mfma_f32_32x32x16_bf16 v[224:239], v[28:31], v[16:19], v[224:239]
  ds_read_b64_tr_b16 v[76:77], v59 offset:36864
  ds_read_b64_tr_b16 v[78:79], v59 offset:37888
  v_mfma_f32_32x32x16_bf16 v[240:255], v[28:31], v[20:23], v[240:255]
  s_waitcnt lgkmcnt(10)
  v_mfma_f32_16x16x32_bf16 v[12:15], v[8:11], v[40:43], v[12:15]
  s_barrier
  s_setprio 2
  ds_read_b64_tr_b16 v[24:25], v58 offset:40960
  ds_read_b64_tr_b16 v[26:27], v58 offset:41984
  s_waitcnt lgkmcnt(11)
  v_mfma_f32_32x32x16_bf16 v[192:207], v[40:43], v[32:35], v[192:207]
  ds_read_b128 v[16:19], v54 offset:32768
  s_waitcnt lgkmcnt(11)
  v_mfma_f32_32x32x16_bf16 v[208:223], v[40:43], v[36:39], v[208:223]
  ds_read_b128 v[20:23], v54 offset:36864
  s_waitcnt lgkmcnt(10)
  v_mfma_f32_32x32x16_bf16 v[224:239], v[44:47], v[32:35], v[224:239]
  ds_read_b64_tr_b16 v[28:29], v59 offset:40960
  ds_read_b64_tr_b16 v[30:31], v59 offset:41984
  v_mfma_f32_32x32x16_bf16 v[240:255], v[44:47], v[36:39], v[240:255]
  ds_read_b64 v[156:157], v2
  ds_read_b64 v[160:161], v2 offset:256
  s_waitcnt lgkmcnt(12)
  v_mfma_f32_16x16x32_bf16 v[12:15], v[8:11], v[72:75], v[12:15]
  ds_read_b64_tr_b16 v[40:41], v58 offset:45056
  ds_read_b64_tr_b16 v[42:43], v58 offset:46080
  s_waitcnt lgkmcnt(13)
  v_mfma_f32_32x32x16_bf16 v[192:207], v[72:75], v[64:67], v[192:207]
  ds_read_b128 v[32:35], v55 offset:32768
  s_waitcnt lgkmcnt(13)
  v_mfma_f32_32x32x16_bf16 v[208:223], v[72:75], v[68:71], v[208:223]
  ds_read_b128 v[36:39], v55 offset:36864
  s_waitcnt lgkmcnt(12)
  v_mfma_f32_32x32x16_bf16 v[224:239], v[76:79], v[64:67], v[224:239]
  ds_read_b64_tr_b16 v[44:45], v59 offset:45056
  ds_read_b64_tr_b16 v[46:47], v59 offset:46080
  v_mfma_f32_32x32x16_bf16 v[240:255], v[76:79], v[68:71], v[240:255]
  ds_read_b128 v[80:83], v61 offset:512
  ds_read_b128 v[84:87], v61 offset:544
  s_waitcnt lgkmcnt(14)
  v_mfma_f32_16x16x32_bf16 v[12:15], v[8:11], v[24:27], v[12:15]
  ds_read_b128 v[88:91], v61 offset:576
  ds_read_b128 v[92:95], v61 offset:608
  s_waitcnt lgkmcnt(15)
  v_mfma_f32_32x32x16_bf16 v[192:207], v[24:27], v[16:19], v[192:207]
  ds_read_b128 v[96:99], v62 offset:512
  ds_read_b128 v[100:103], v62 offset:544
  s_waitcnt lgkmcnt(15)
  v_mfma_f32_32x32x16_bf16 v[208:223], v[24:27], v[20:23], v[208:223]
  ds_read_b128 v[104:107], v62 offset:576
  ds_read_b128 v[108:111], v62 offset:608
  s_waitcnt lgkmcnt(15)
  v_mfma_f32_32x32x16_bf16 v[224:239], v[28:31], v[16:19], v[224:239]
  s_waitcnt lgkmcnt(14)
  v_sub_f32 v158, 0, v157
  v_sub_f32 v159, 0, v157
  v_mov_b32 v157, v156
  v_sub_f32 v162, 0, v161
  v_sub_f32 v163, 0, v161
  v_mov_b32 v161, v160
  v_mfma_f32_32x32x16_bf16 v[240:255], v[28:31], v[20:23], v[240:255]
  s_waitcnt lgkmcnt(12)
  v_mfma_f32_16x16x32_bf16 v[12:15], v[8:11], v[40:43], v[12:15]
  s_waitcnt lgkmcnt(11)
  v_mfma_f32_32x32x16_bf16 v[192:207], v[40:43], v[32:35], v[192:207]
  s_waitcnt lgkmcnt(10)
  v_mfma_f32_32x32x16_bf16 v[208:223], v[40:43], v[36:39], v[208:223]
  s_mov_b64 exec, 0xffff
  s_nop 2
  ds_write2_b32 v1, v12, v13 offset0:0 offset1:16
  s_mov_b64 exec, -1
  s_waitcnt lgkmcnt(9)
  v_mfma_f32_32x32x16_bf16 v[224:239], v[44:47], v[32:35], v[224:239]
  s_mov_b64 exec, 1
  ds_add_u32 v4, v5
  s_mov_b64 exec, -1
  ds_read_b128 v[112:115], v61 offset:0
  ds_read_b128 v[116:119], v61 offset:32
  ds_read_b128 v[120:123], v61 offset:64
  ds_read_b128 v[124:127], v61 offset:96
  v_mfma_f32_32x32x16_bf16 v[240:255], v[44:47], v[36:39], v[240:255]
  s_waitcnt lgkmcnt(0)
  v_pk_fma_f32 v[48:49], v[112:113], v[158:159], v[80:81]
  v_pk_fma_f32 v[50:51], v[114:115], v[158:159], v[82:83]
  v_pk_fma_f32 v[52:53], v[116:117], v[158:159], v[84:85]
  v_pk_fma_f32 v[54:55], v[118:119], v[158:159], v[86:87]
  v_pk_fma_f32 v[192:193], v[192:193], v[156:157], v[48:49]
  v_pk_fma_f32 v[194:195], v[194:195], v[156:157], v[50:51]
  v_pk_fma_f32 v[196:197], v[196:197], v[156:157], v[52:53]
  v_pk_fma_f32 v[198:199], v[198:199], v[156:157], v[54:55]
  v_pk_mul_f32 v[48:49], v[192:193], v[192:193]
  v_pk_mul_f32 v[50:51], v[194:195], v[194:195]
  v_pk_mul_f32 v[52:53], v[196:197], v[196:197]
  v_pk_mul_f32 v[54:55], v[198:199], v[198:199]
  v_pk_fma_f32 v[48:49], v[48:49], s[14:15], v[164:165]
  v_pk_fma_f32 v[50:51], v[50:51], s[14:15], v[164:165]
  v_pk_fma_f32 v[52:53], v[52:53], s[14:15], v[164:165]
  v_pk_fma_f32 v[54:55], v[54:55], s[14:15], v[164:165]
  v_pk_mul_f32 v[48:49], v[48:49], v[192:193]
  v_pk_mul_f32 v[50:51], v[50:51], v[194:195]
  v_pk_mul_f32 v[52:53], v[52:53], v[196:197]
  v_pk_mul_f32 v[54:55], v[54:55], v[198:199]
  v_exp_f32 v48, v48
  v_exp_f32 v49, v49
  v_exp_f32 v50, v50
  v_exp_f32 v51, v51
  v_exp_f32 v52, v52
  v_exp_f32 v53, v53
  v_exp_f32 v54, v54
  v_exp_f32 v55, v55
  v_pk_add_f32 v[48:49], v[48:49], v[166:167]
  v_pk_add_f32 v[50:51], v[50:51], v[166:167]
  v_pk_add_f32 v[52:53], v[52:53], v[166:167]
  v_pk_add_f32 v[54:55], v[54:55], v[166:167]
  v_rcp_f32 v48, v48
  v_rcp_f32 v49, v49
  v_rcp_f32 v50, v50
  v_rcp_f32 v51, v51
  v_rcp_f32 v52, v52
  v_rcp_f32 v53, v53
  v_rcp_f32 v54, v54
  v_rcp_f32 v55, v55
  v_pk_mul_f32 v[48:49], v[192:193], v[48:49]
  v_pk_mul_f32 v[50:51], v[194:195], v[50:51]
  v_pk_mul_f32 v[52:53], v[196:197], v[52:53]
  v_pk_mul_f32 v[54:55], v[198:199], v[54:55]
  v_cvt_pk_bf16_f32 v192, v48, v49
  v_cvt_pk_bf16_f32 v193, v50, v51
  v_cvt_pk_bf16_f32 v194, v52, v53
  v_cvt_pk_bf16_f32 v195, v54, v55
  s_add_u32 s11, s98, 0
  buffer_store_dwordx4 v[192:195], v60, s[64:67], s11 offen sc1
  v_pk_fma_f32 v[48:49], v[112:113], v[162:163], v[80:81]
  v_pk_fma_f32 v[50:51], v[114:115], v[162:163], v[82:83]
  v_pk_fma_f32 v[52:53], v[116:117], v[162:163], v[84:85]
  v_pk_fma_f32 v[54:55], v[118:119], v[162:163], v[86:87]
  v_pk_fma_f32 v[208:209], v[208:209], v[160:161], v[48:49]
  v_pk_fma_f32 v[210:211], v[210:211], v[160:161], v[50:51]
  v_pk_fma_f32 v[212:213], v[212:213], v[160:161], v[52:53]
  v_pk_fma_f32 v[214:215], v[214:215], v[160:161], v[54:55]
  v_pk_mul_f32 v[48:49], v[208:209], v[208:209]
  v_pk_mul_f32 v[50:51], v[210:211], v[210:211]
  v_pk_mul_f32 v[52:53], v[212:213], v[212:213]
  v_pk_mul_f32 v[54:55], v[214:215], v[214:215]
  v_pk_fma_f32 v[48:49], v[48:49], s[14:15], v[164:165]
  v_pk_fma_f32 v[50:51], v[50:51], s[14:15], v[164:165]
  v_pk_fma_f32 v[52:53], v[52:53], s[14:15], v[164:165]
  v_pk_fma_f32 v[54:55], v[54:55], s[14:15], v[164:165]
  v_pk_mul_f32 v[48:49], v[48:49], v[208:209]
  v_pk_mul_f32 v[50:51], v[50:51], v[210:211]
  v_pk_mul_f32 v[52:53], v[52:53], v[212:213]
  v_pk_mul_f32 v[54:55], v[54:55], v[214:215]
  v_exp_f32 v48, v48
  v_exp_f32 v49, v49
  v_exp_f32 v50, v50
  v_exp_f32 v51, v51
  v_exp_f32 v52, v52
  v_exp_f32 v53, v53
  v_exp_f32 v54, v54
  v_exp_f32 v55, v55
  v_pk_add_f32 v[48:49], v[48:49], v[166:167]
  v_pk_add_f32 v[50:51], v[50:51], v[166:167]
  v_pk_add_f32 v[52:53], v[52:53], v[166:167]
  v_pk_add_f32 v[54:55], v[54:55], v[166:167]
  v_rcp_f32 v48, v48
  v_rcp_f32 v49, v49
  v_rcp_f32 v50, v50
  v_rcp_f32 v51, v51
  v_rcp_f32 v52, v52
  v_rcp_f32 v53, v53
  v_rcp_f32 v54, v54
  v_rcp_f32 v55, v55
  v_pk_mul_f32 v[48:49], v[208:209], v[48:49]
  v_pk_mul_f32 v[50:51], v[210:211], v[50:51]
  v_pk_mul_f32 v[52:53], v[212:213], v[52:53]
  v_pk_mul_f32 v[54:55], v[214:215], v[54:55]
  v_cvt_pk_bf16_f32 v208, v48, v49
  v_cvt_pk_bf16_f32 v209, v50, v51
  v_cvt_pk_bf16_f32 v210, v52, v53
  v_cvt_pk_bf16_f32 v211, v54, v55
  s_add_u32 s11, s98, 114688
  buffer_store_dwordx4 v[208:211], v60, s[64:67], s11 offen sc1
  s_mov_b32 s12, 262144
isp_7:
  ds_read_b32 v6, v4
  s_sub_u32 s12, s12, 1
  s_waitcnt lgkmcnt(0)
  v_readfirstlane_b32 s11, v6
  s_nop 0
  s_cselect_b32 s61, -1, s11
  s_cmp_lt_u32 s61, 40
  s_cbranch_scc1 isp_7
  ds_read_b128 v[128:131], v62 offset:0
  ds_read_b128 v[132:135], v62 offset:32
  ds_read_b128 v[136:139], v62 offset:64
  ds_read_b128 v[140:143], v62 offset:96
  v_pk_fma_f32 v[48:49], v[120:121], v[158:159], v[88:89]
  v_pk_fma_f32 v[50:51], v[122:123], v[158:159], v[90:91]
  v_pk_fma_f32 v[52:53], v[124:125], v[158:159], v[92:93]
  v_pk_fma_f32 v[54:55], v[126:127], v[158:159], v[94:95]
  v_pk_fma_f32 v[200:201], v[200:201], v[156:157], v[48:49]
  v_pk_fma_f32 v[202:203], v[202:203], v[156:157], v[50:51]
  v_pk_fma_f32 v[204:205], v[204:205], v[156:157], v[52:53]
  v_pk_fma_f32 v[206:207], v[206:207], v[156:157], v[54:55]
  v_pk_mul_f32 v[48:49], v[200:201], v[200:201]
  v_pk_mul_f32 v[50:51], v[202:203], v[202:203]
  v_pk_mul_f32 v[52:53], v[204:205], v[204:205]
  v_pk_mul_f32 v[54:55], v[206:207], v[206:207]
  v_pk_fma_f32 v[48:49], v[48:49], s[14:15], v[164:165]
  v_pk_fma_f32 v[50:51], v[50:51], s[14:15], v[164:165]
  v_pk_fma_f32 v[52:53], v[52:53], s[14:15], v[164:165]
  v_pk_fma_f32 v[54:55], v[54:55], s[14:15], v[164:165]
  v_pk_mul_f32 v[48:49], v[48:49], v[200:201]
  v_pk_mul_f32 v[50:51], v[50:51], v[202:203]
  v_pk_mul_f32 v[52:53], v[52:53], v[204:205]
  v_pk_mul_f32 v[54:55], v[54:55], v[206:207]
  v_exp_f32 v48, v48
  v_exp_f32 v49, v49
  v_exp_f32 v50, v50
  v_exp_f32 v51, v51
  v_exp_f32 v52, v52
  v_exp_f32 v53, v53
  v_exp_f32 v54, v54
  v_exp_f32 v55, v55
  v_pk_add_f32 v[48:49], v[48:49], v[166:167]
  v_pk_add_f32 v[50:51], v[50:51], v[166:167]
  v_pk_add_f32 v[52:53], v[52:53], v[166:167]
  v_pk_add_f32 v[54:55], v[54:55], v[166:167]
  v_rcp_f32 v48, v48
  v_rcp_f32 v49, v49
  v_rcp_f32 v50, v50
  v_rcp_f32 v51, v51
  v_rcp_f32 v52, v52
  v_rcp_f32 v53, v53
  v_rcp_f32 v54, v54
  v_rcp_f32 v55, v55
  v_pk_mul_f32 v[48:49], v[200:201], v[48:49]
  v_pk_mul_f32 v[50:51], v[202:203], v[50:51]
  v_pk_mul_f32 v[52:53], v[204:205], v[52:53]
  v_pk_mul_f32 v[54:55], v[206:207], v[54:55]
  v_cvt_pk_bf16_f32 v200, v48, v49
  v_cvt_pk_bf16_f32 v201, v50, v51
  v_cvt_pk_bf16_f32 v202, v52, v53
  v_cvt_pk_bf16_f32 v203, v54, v55
  s_add_u32 s11, s98, 1024
  buffer_store_dwordx4 v[200:203], v60, s[64:67], s11 offen sc1
  v_pk_fma_f32 v[48:49], v[120:121], v[162:163], v[88:89]
  v_pk_fma_f32 v[50:51], v[122:123], v[162:163], v[90:91]
  v_pk_fma_f32 v[52:53], v[124:125], v[162:163], v[92:93]
  v_pk_fma_f32 v[54:55], v[126:127], v[162:163], v[94:95]
  v_pk_fma_f32 v[216:217], v[216:217], v[160:161], v[48:49]
  v_pk_fma_f32 v[218:219], v[218:219], v[160:161], v[50:51]
  v_pk_fma_f32 v[220:221], v[220:221], v[160:161], v[52:53]
  v_pk_fma_f32 v[222:223], v[222:223], v[160:161], v[54:55]
  v_pk_mul_f32 v[48:49], v[216:217], v[216:217]
  v_pk_mul_f32 v[50:51], v[218:219], v[218:219]
  v_pk_mul_f32 v[52:53], v[220:221], v[220:221]
  v_pk_mul_f32 v[54:55], v[222:223], v[222:223]
  v_pk_fma_f32 v[48:49], v[48:49], s[14:15], v[164:165]
  v_pk_fma_f32 v[50:51], v[50:51], s[14:15], v[164:165]
  v_pk_fma_f32 v[52:53], v[52:53], s[14:15], v[164:165]
  v_pk_fma_f32 v[54:55], v[54:55], s[14:15], v[164:165]
  v_pk_mul_f32 v[48:49], v[48:49], v[216:217]
  v_pk_mul_f32 v[50:51], v[50:51], v[218:219]
  v_pk_mul_f32 v[52:53], v[52:53], v[220:221]
  v_pk_mul_f32 v[54:55], v[54:55], v[222:223]
  v_exp_f32 v48, v48
  v_exp_f32 v49, v49
  v_exp_f32 v50, v50
  v_exp_f32 v51, v51
  v_exp_f32 v52, v52
  v_exp_f32 v53, v53
  v_exp_f32 v54, v54
  v_exp_f32 v55, v55
  v_pk_add_f32 v[48:49], v[48:49], v[166:167]
  v_pk_add_f32 v[50:51], v[50:51], v[166:167]
  v_pk_add_f32 v[52:53], v[52:53], v[166:167]
  v_pk_add_f32 v[54:55], v[54:55], v[166:167]
  v_rcp_f32 v48, v48
  v_rcp_f32 v49, v49
  v_rcp_f32 v50, v50
  v_rcp_f32 v51, v51
  v_rcp_f32 v52, v52
  v_rcp_f32 v53, v53
  v_rcp_f32 v54, v54
  v_rcp_f32 v55, v55
  v_pk_mul_f32 v[48:49], v[216:217], v[48:49]
  v_pk_mul_f32 v[50:51], v[218:219], v[50:51]
  v_pk_mul_f32 v[52:53], v[220:221], v[52:53]
  v_pk_mul_f32 v[54:55], v[222:223], v[54:55]
  v_cvt_pk_bf16_f32 v216, v48, v49
  v_cvt_pk_bf16_f32 v217, v50, v51
  v_cvt_pk_bf16_f32 v218, v52, v53
  v_cvt_pk_bf16_f32 v219, v54, v55
  s_add_u32 s11, s98, 115712
  buffer_store_dwordx4 v[216:219], v60, s[64:67], s11 offen sc1
  s_waitcnt lgkmcnt(0)
  v_pk_fma_f32 v[48:49], v[128:129], v[158:159], v[96:97]
  v_pk_fma_f32 v[50:51], v[130:131], v[158:159], v[98:99]
  v_pk_fma_f32 v[52:53], v[132:133], v[158:159], v[100:101]
  v_pk_fma_f32 v[54:55], v[134:135], v[158:159], v[102:103]
  v_pk_fma_f32 v[224:225], v[224:225], v[156:157], v[48:49]
  v_pk_fma_f32 v[226:227], v[226:227], v[156:157], v[50:51]
  v_pk_fma_f32 v[228:229], v[228:229], v[156:157], v[52:53]
  v_pk_fma_f32 v[230:231], v[230:231], v[156:157], v[54:55]
  v_pk_mul_f32 v[48:49], v[224:225], v[224:225]
  v_pk_mul_f32 v[50:51], v[226:227], v[226:227]
  v_pk_mul_f32 v[52:53], v[228:229], v[228:229]
  v_pk_mul_f32 v[54:55], v[230:231], v[230:231]
  v_pk_fma_f32 v[48:49], v[48:49], s[14:15], v[164:165]
  v_pk_fma_f32 v[50:51], v[50:51], s[14:15], v[164:165]
  v_pk_fma_f32 v[52:53], v[52:53], s[14:15], v[164:165]
  v_pk_fma_f32 v[54:55], v[54:55], s[14:15], v[164:165]
  v_pk_mul_f32 v[48:49], v[48:49], v[224:225]
  v_pk_mul_f32 v[50:51], v[50:51], v[226:227]
  v_pk_mul_f32 v[52:53], v[52:53], v[228:229]
  v_pk_mul_f32 v[54:55], v[54:55], v[230:231]
  v_exp_f32 v48, v48
  v_exp_f32 v49, v49
  v_exp_f32 v50, v50
  v_exp_f32 v51, v51
  v_exp_f32 v52, v52
  v_exp_f32 v53, v53
  v_exp_f32 v54, v54
  v_exp_f32 v55, v55
  v_pk_add_f32 v[48:49], v[48:49], v[166:167]
  v_pk_add_f32 v[50:51], v[50:51], v[166:167]
  v_pk_add_f32 v[52:53], v[52:53], v[166:167]
  v_pk_add_f32 v[54:55], v[54:55], v[166:167]
  v_rcp_f32 v48, v48
  v_rcp_f32 v49, v49
  v_rcp_f32 v50, v50
  v_rcp_f32 v51, v51
  v_rcp_f32 v52, v52
  v_rcp_f32 v53, v53
  v_rcp_f32 v54, v54
  v_rcp_f32 v55, v55
  v_pk_mul_f32 v[48:49], v[224:225], v[48:49]
  v_pk_mul_f32 v[50:51], v[226:227], v[50:51]
  v_pk_mul_f32 v[52:53], v[228:229], v[52:53]
  v_pk_mul_f32 v[54:55], v[230:231], v[54:55]
  v_cvt_pk_bf16_f32 v224, v48, v49
  v_cvt_pk_bf16_f32 v225, v50, v51
  v_cvt_pk_bf16_f32 v226, v52, v53
  v_cvt_pk_bf16_f32 v227, v54, v55
  s_add_u32 s11, s99, 0
  buffer_store_dwordx4 v[224:227], v60, s[64:67], s11 offen sc1
  v_pk_fma_f32 v[48:49], v[128:129], v[162:163], v[96:97]
  v_pk_fma_f32 v[50:51], v[130:131], v[162:163], v[98:99]
  v_pk_fma_f32 v[52:53], v[132:133], v[162:163], v[100:101]
  v_pk_fma_f32 v[54:55], v[134:135], v[162:163], v[102:103]
  v_pk_fma_f32 v[240:241], v[240:241], v[160:161], v[48:49]
  v_pk_fma_f32 v[242:243], v[242:243], v[160:161], v[50:51]
  v_pk_fma_f32 v[244:245], v[244:245], v[160:161], v[52:53]
  v_pk_fma_f32 v[246:247], v[246:247], v[160:161], v[54:55]
  v_pk_mul_f32 v[48:49], v[240:241], v[240:241]
  v_pk_mul_f32 v[50:51], v[242:243], v[242:243]
  v_pk_mul_f32 v[52:53], v[244:245], v[244:245]
  v_pk_mul_f32 v[54:55], v[246:247], v[246:247]
  v_pk_fma_f32 v[48:49], v[48:49], s[14:15], v[164:165]
  v_pk_fma_f32 v[50:51], v[50:51], s[14:15], v[164:165]
  v_pk_fma_f32 v[52:53], v[52:53], s[14:15], v[164:165]
  v_pk_fma_f32 v[54:55], v[54:55], s[14:15], v[164:165]
  v_pk_mul_f32 v[48:49], v[48:49], v[240:241]
  v_pk_mul_f32 v[50:51], v[50:51], v[242:243]
  v_pk_mul_f32 v[52:53], v[52:53], v[244:245]
  v_pk_mul_f32 v[54:55], v[54:55], v[246:247]
  v_exp_f32 v48, v48
  v_exp_f32 v49, v49
  v_exp_f32 v50, v50
  v_exp_f32 v51, v51
  v_exp_f32 v52, v52
  v_exp_f32 v53, v53
  v_exp_f32 v54, v54
  v_exp_f32 v55, v55
  v_pk_add_f32 v[48:49], v[48:49], v[166:167]
  v_pk_add_f32 v[50:51], v[50:51], v[166:167]
  v_pk_add_f32 v[52:53], v[52:53], v[166:167]
  v_pk_add_f32 v[54:55], v[54:55], v[166:167]
  v_rcp_f32 v48, v48
  v_rcp_f32 v49, v49
  v_rcp_f32 v50, v50
  v_rcp_f32 v51, v51
  v_rcp_f32 v52, v52
  v_rcp_f32 v53, v53
  v_rcp_f32 v54, v54
  v_rcp_f32 v55, v55
  v_pk_mul_f32 v[48:49], v[240:241], v[48:49]
  v_pk_mul_f32 v[50:51], v[242:243], v[50:51]
  v_pk_mul_f32 v[52:53], v[244:245], v[52:53]
  v_pk_mul_f32 v[54:55], v[246:247], v[54:55]
  v_cvt_pk_bf16_f32 v240, v48, v49
  v_cvt_pk_bf16_f32 v241, v50, v51
  v_cvt_pk_bf16_f32 v242, v52, v53
  v_cvt_pk_bf16_f32 v243, v54, v55
  s_add_u32 s11, s99, 114688
  buffer_store_dwordx4 v[240:243], v60, s[64:67], s11 offen sc1
  v_pk_fma_f32 v[48:49], v[136:137], v[158:159], v[104:105]
  v_pk_fma_f32 v[50:51], v[138:139], v[158:159], v[106:107]
  v_pk_fma_f32 v[52:53], v[140:141], v[158:159], v[108:109]
  v_pk_fma_f32 v[54:55], v[142:143], v[158:159], v[110:111]
  v_pk_fma_f32 v[232:233], v[232:233], v[156:157], v[48:49]
  v_pk_fma_f32 v[234:235], v[234:235], v[156:157], v[50:51]
  v_pk_fma_f32 v[236:237], v[236:237], v[156:157], v[52:53]
  v_pk_fma_f32 v[238:239], v[238:239], v[156:157], v[54:55]
  v_pk_mul_f32 v[48:49], v[232:233], v[232:233]
  v_pk_mul_f32 v[50:51], v[234:235], v[234:235]
  v_pk_mul_f32 v[52:53], v[236:237], v[236:237]
  v_pk_mul_f32 v[54:55], v[238:239], v[238:239]
  v_pk_fma_f32 v[48:49], v[48:49], s[14:15], v[164:165]
  v_pk_fma_f32 v[50:51], v[50:51], s[14:15], v[164:165]
  v_pk_fma_f32 v[52:53], v[52:53], s[14:15], v[164:165]
  v_pk_fma_f32 v[54:55], v[54:55], s[14:15], v[164:165]
  v_pk_mul_f32 v[48:49], v[48:49], v[232:233]
  v_pk_mul_f32 v[50:51], v[50:51], v[234:235]
  v_pk_mul_f32 v[52:53], v[52:53], v[236:237]
  v_pk_mul_f32 v[54:55], v[54:55], v[238:239]
  v_exp_f32 v48, v48
  v_exp_f32 v49, v49
  v_exp_f32 v50, v50
  v_exp_f32 v51, v51
  v_exp_f32 v52, v52
  v_exp_f32 v53, v53
  v_exp_f32 v54, v54
  v_exp_f32 v55, v55
  v_pk_add_f32 v[48:49], v[48:49], v[166:167]
  v_pk_add_f32 v[50:51], v[50:51], v[166:167]
  v_pk_add_f32 v[52:53], v[52:53], v[166:167]
  v_pk_add_f32 v[54:55], v[54:55], v[166:167]
  v_rcp_f32 v48, v48
  v_rcp_f32 v49, v49
  v_rcp_f32 v50, v50
  v_rcp_f32 v51, v51
  v_rcp_f32 v52, v52
  v_rcp_f32 v53, v53
  v_rcp_f32 v54, v54
  v_rcp_f32 v55, v55
  v_pk_mul_f32 v[48:49], v[232:233], v[48:49]
  v_pk_mul_f32 v[50:51], v[234:235], v[50:51]
  v_pk_mul_f32 v[52:53], v[236:237], v[52:53]
  v_pk_mul_f32 v[54:55], v[238:239], v[54:55]
  v_cvt_pk_bf16_f32 v232, v48, v49
  v_cvt_pk_bf16_f32 v233, v50, v51
  v_cvt_pk_bf16_f32 v234, v52, v53
  v_cvt_pk_bf16_f32 v235, v54, v55
  s_add_u32 s11, s99, 1024
  buffer_store_dwordx4 v[232:235], v60, s[64:67], s11 offen sc1
  v_pk_fma_f32 v[48:49], v[136:137], v[162:163], v[104:105]
  v_pk_fma_f32 v[50:51], v[138:139], v[162:163], v[106:107]
  v_pk_fma_f32 v[52:53], v[140:141], v[162:163], v[108:109]
  v_pk_fma_f32 v[54:55], v[142:143], v[162:163], v[110:111]
  v_pk_fma_f32 v[248:249], v[248:249], v[160:161], v[48:49]
  v_pk_fma_f32 v[250:251], v[250:251], v[160:161], v[50:51]
  v_pk_fma_f32 v[252:253], v[252:253], v[160:161], v[52:53]
  v_pk_fma_f32 v[254:255], v[254:255], v[160:161], v[54:55]
  v_pk_mul_f32 v[48:49], v[248:249], v[248:249]
  v_pk_mul_f32 v[50:51], v[250:251], v[250:251]
  v_pk_mul_f32 v[52:53], v[252:253], v[252:253]
  v_pk_mul_f32 v[54:55], v[254:255], v[254:255]
  v_pk_fma_f32 v[48:49], v[48:49], s[14:15], v[164:165]
  v_pk_fma_f32 v[50:51], v[50:51], s[14:15], v[164:165]
  v_pk_fma_f32 v[52:53], v[52:53], s[14:15], v[164:165]
  v_pk_fma_f32 v[54:55], v[54:55], s[14:15], v[164:165]
  v_pk_mul_f32 v[48:49], v[48:49], v[248:249]
  v_pk_mul_f32 v[50:51], v[50:51], v[250:251]
  v_pk_mul_f32 v[52:53], v[52:53], v[252:253]
  v_pk_mul_f32 v[54:55], v[54:55], v[254:255]
  v_exp_f32 v48, v48
  v_exp_f32 v49, v49
  v_exp_f32 v50, v50
  v_exp_f32 v51, v51
  v_exp_f32 v52, v52
  v_exp_f32 v53, v53
  v_exp_f32 v54, v54
  v_exp_f32 v55, v55
  v_pk_add_f32 v[48:49], v[48:49], v[166:167]
  v_pk_add_f32 v[50:51], v[50:51], v[166:167]
  v_pk_add_f32 v[52:53], v[52:53], v[166:167]
  v_pk_add_f32 v[54:55], v[54:55], v[166:167]
  v_rcp_f32 v48, v48
  v_rcp_f32 v49, v49
  v_rcp_f32 v50, v50
  v_rcp_f32 v51, v51
  v_rcp_f32 v52, v52
  v_rcp_f32 v53, v53
  v_rcp_f32 v54, v54
  v_rcp_f32 v55, v55
  v_pk_mul_f32 v[48:49], v[248:249], v[48:49]
  v_pk_mul_f32 v[50:51], v[250:251], v[50:51]
  v_pk_mul_f32 v[52:53], v[252:253], v[52:53]
  v_pk_mul_f32 v[54:55], v[254:255], v[54:55]
  v_cvt_pk_bf16_f32 v248, v48, v49
  v_cvt_pk_bf16_f32 v249, v50, v51
  v_cvt_pk_bf16_f32 v250, v52, v53
  v_cvt_pk_bf16_f32 v251, v54, v55
  s_add_u32 s11, s99, 115712
  buffer_store_dwordx4 v[248:251], v60, s[64:67], s11 offen sc1
  s_lshl_b32 s11, s3, 2
  s_add_u32 s11, s11, 163472
  v_mov_b32 v10, s11
  v_mov_b32 v11, 1
  ds_write_b32 v10, v11
  s_lshl_b32 s94, s9, 2
  s_add_u32 s94, s94, s3
  s_add_u32 s94, s94, 137
  s_lshl_b32 s11, s94, 6
  s_add_u32 s11, s11, 15007744
  s_load_dword s35, s[48:49], s11
  s_lshl_b32 s12, s7, 1
  s_add_u32 s12, s12, s68
  s_mul_i32 s13, s12, 37
  s_lshr_b32 s13, s13, 8
  s_lshl_b32 s11, s6, 1
  s_add_u32 s11, s11, s69
  s_lshl_b32 s11, s11, 2
  s_add_u32 s99, s11, s13
  s_mul_i32 s11, s13, 7
  s_sub_u32 s12, s12, s11
  s_lshl_b32 s12, s12, 2
  s_lshl_b32 s11, s99, 6
  s_add_u32 s11, s11, s12
  s_add_u32 s11, s11, 14745600
  v_lshlrev_b32 v10, 14, v0
  v_add_u32 v10, s11, v10
  v_mov_b32 v11, s10
  s_waitcnt vmcnt(0)
  s_mov_b64 exec, 255
  global_store_dword v10, v11, s[48:49] sc1
  s_mov_b64 exec, -1
  s_waitcnt lgkmcnt(0)
  s_cmp_lg_u32 s35, s10
  s_cbranch_scc1 slow_8
back_9:
  s_lshl_b32 s11, s3, 2
  s_add_u32 s11, s11, 163472
  v_mov_b32 v10, s11
  v_mov_b32 v11, 2
  ds_write_b32 v10, v11
L_G2JOIN:
  s_setprio 0
  s_lshl_b32 s11, s3, 4
  s_lshl_b32 s12, s8, 6
  s_add_u32 s11, s11, s12
  s_lshl_b32 s11, s11, 10
  s_lshl_b32 s12, s9, 7
  s_add_u32 s11, s11, s12
  v_and_b32 v2, 7, v0
  v_lshlrev_b32 v2, 4, v2
  v_lshrrev_b32 v1, 3, v0
  v_lshl_add_u32 v1, v1, 10, v2
  v_add_u32 v1, s11, v1
  v_add_u32 v2, s12, v2
  v_add_u32 v61, 0x2000, v1
  s_mov_b32 s14, s16
  s_mov_b32 s15, s17
  s_add_u32 s11, s50, 0
  buffer_load_dwordx4 v[80:83], v60, s[64:67], s11 offen offset:0 sc1
  s_add_u32 s11, s52, 0
  buffer_load_dwordx4 v[84:87], v60, s[64:67], s11 offen offset:0 sc1
  s_add_u32 s11, s50, 0
  buffer_load_dwordx4 v[88:91], v60, s[64:67], s11 offen offset:1024 sc1
  s_add_u32 s11, s52, 0
  buffer_load_dwordx4 v[92:95], v60, s[64:67], s11 offen offset:1024 sc1
  s_add_u32 s11, s50, 0
  buffer_load_dwordx4 v[96:99], v60, s[64:67], s11 offen offset:2048 sc1
  s_add_u32 s11, s52, 0
  buffer_load_dwordx4 v[100:103], v60, s[64:67], s11 offen offset:2048 sc1
  s_add_u32 s11, s50, 0
  buffer_load_dwordx4 v[104:107], v60, s[64:67], s11 offen offset:3072 sc1
  s_add_u32 s11, s52, 0
  buffer_load_dwordx4 v[108:111], v60, s[64:67], s11 offen offset:3072 sc1
  s_add_u32 s11, s50, 4096
  buffer_load_dwordx4 v[112:115], v60, s[64:67], s11 offen offset:0 sc1
  s_add_u32 s11, s52, 4096
  buffer_load_dwordx4 v[116:119], v60, s[64:67], s11 offen offset:0 sc1
  s_add_u32 s11, s50, 4096
  buffer_load_dwordx4 v[120:123], v60, s[64:67], s11 offen offset:1024 sc1
  s_add_u32 s11, s52, 4096
  buffer_load_dwordx4 v[124:127], v60, s[64:67], s11 offen offset:1024 sc1
  s_add_u32 s11, s50, 4096
  buffer_load_dwordx4 v[128:131], v60, s[64:67], s11 offen offset:2048 sc1
  s_add_u32 s11, s52, 4096
  buffer_load_dwordx4 v[132:135], v60, s[64:67], s11 offen offset:2048 sc1
  s_add_u32 s11, s50, 4096
  buffer_load_dwordx4 v[136:139], v60, s[64:67], s11 offen offset:3072 sc1
  s_add_u32 s11, s52, 4096
  buffer_load_dwordx4 v[140:143], v60, s[64:67], s11 offen offset:3072 sc1
  s_add_u32 s11, s50, 8192
  buffer_load_dwordx4 v[144:147], v60, s[64:67], s11 offen offset:0 sc1
  s_add_u32 s11, s52, 8192
  buffer_load_dwordx4 v[148:151], v60, s[64:67], s11 offen offset:0 sc1
  s_add_u32 s11, s50, 8192
  buffer_load_dwordx4 v[152:155], v60, s[64:67], s11 offen offset:1024 sc1
  s_add_u32 s11, s52, 8192
  buffer_load_dwordx4 v[156:159], v60, s[64:67], s11 offen offset:1024 sc1
  s_add_u32 s11, s50, 8192
  buffer_load_dwordx4 v[160:163], v60, s[64:67], s11 offen offset:2048 sc1
  s_add_u32 s11, s52, 8192
  buffer_load_dwordx4 v[164:167], v60, s[64:67], s11 offen offset:2048 sc1
  s_add_u32 s11, s50, 8192
  buffer_load_dwordx4 v[168:171], v60, s[64:67], s11 offen offset:3072 sc1
  s_add_u32 s11, s52, 8192
  buffer_load_dwordx4 v[172:175], v60, s[64:67], s11 offen offset:3072 sc1
  s_add_u32 s11, s50, 12288
  buffer_load_dwordx4 v[176:179], v60, s[64:67], s11 offen offset:0 sc1
  s_add_u32 s11, s52, 12288
  buffer_load_dwordx4 v[180:183], v60, s[64:67], s11 offen offset:0 sc1
  s_add_u32 s11, s50, 12288
  buffer_load_dwordx4 v[184:187], v60, s[64:67], s11 offen offset:1024 sc1
  s_add_u32 s11, s52, 12288
  buffer_load_dwordx4 v[188:191], v60, s[64:67], s11 offen offset:1024 sc1
  s_add_u32 s11, s50, 12288
  buffer_load_dwordx4 v[64:67], v60, s[64:67], s11 offen offset:2048 sc1
  s_add_u32 s11, s52, 12288
  buffer_load_dwordx4 v[68:71], v60, s[64:67], s11 offen offset:2048 sc1
  s_add_u32 s11, s50, 12288
  buffer_load_dwordx4 v[72:75], v60, s[64:67], s11 offen offset:3072 sc1
  s_add_u32 s11, s52, 12288
  buffer_load_dwordx4 v[76:79], v60, s[64:67], s11 offen offset:3072 sc1
  s_lshl_b32 s13, s3, 11
  s_lshl_b32 s11, s8, 2
  s_add_u32 s99, s11, s3
  s_add_u32 m0, s13, 24576
  s_add_u32 s11, s50, 19456
  buffer_load_dwordx4 v60, s[64:67], s11 offen sc1 lds
  s_add_u32 m0, s13, 25600
  s_add_u32 s11, s52, 19456
  buffer_load_dwordx4 v60, s[64:67], s11 offen sc1 lds
  s_add_u32 m0, s13, 32768
  s_add_u32 s11, s50, 20480
  buffer_load_dwordx4 v60, s[64:67], s11 offen sc1 lds
  s_add_u32 m0, s13, 33792
  s_add_u32 s11, s52, 20480
  buffer_load_dwordx4 v60, s[64:67], s11 offen sc1 lds
  s_add_u32 m0, s13, 40960
  s_add_u32 s11, s50, 21504
  buffer_load_dwordx4 v60, s[64:67], s11 offen sc1 lds
  s_add_u32 m0, s13, 41984
  s_add_u32 s11, s52, 21504
  buffer_load_dwordx4 v60, s[64:67], s11 offen sc1 lds
  s_add_u32 m0, s13, 65536
  s_add_u32 s11, s50, 24576
  buffer_load_dwordx4 v60, s[64:67], s11 offen sc1 lds
  s_add_u32 m0, s13, 66560
  s_add_u32 s11, s52, 24576
  buffer_load_dwordx4 v60, s[64:67], s11 offen sc1 lds
  s_add_u32 m0, s13, 73728
  s_add_u32 s11, s50, 25600
  buffer_load_dwordx4 v60, s[64:67], s11 offen sc1 lds
  s_waitcnt vmcnt(40)
  s_add_u32 m0, s13, 74752
  s_add_u32 s11, s52, 25600
  buffer_load_dwordx4 v60, s[64:67], s11 offen sc1 lds
  s_waitcnt vmcnt(40)
  s_add_u32 m0, s13, 81920
  s_add_u32 s11, s50, 26624
  buffer_load_dwordx4 v60, s[64:67], s11 offen sc1 lds
  s_waitcnt vmcnt(40)
  s_add_u32 m0, s13, 82944
  s_add_u32 s11, s52, 26624
  buffer_load_dwordx4 v60, s[64:67], s11 offen sc1 lds
  s_waitcnt vmcnt(40)
  s_add_u32 m0, s13, 90112
  s_add_u32 s11, s50, 27648
  buffer_load_dwordx4 v60, s[64:67], s11 offen sc1 lds
  s_waitcnt vmcnt(40)
  s_add_u32 m0, s13, 91136
  s_add_u32 s11, s52, 27648
  buffer_load_dwordx4 v60, s[64:67], s11 offen sc1 lds
  v_mov_b32 v4, 163412
  s_mov_b32 s12, 262144
isp_10:
  ds_read_b32 v5, v4
  s_sub_u32 s12, s12, 1
  s_waitcnt lgkmcnt(0)
  v_readfirstlane_b32 s11, v5
  s_nop 0
  s_cselect_b32 s61, -1, s11
  s_cmp_lt_u32 s61, 4
  s_cbranch_scc1 isp_10
  s_lshl_b32 s11, s3, 2
  s_add_u32 s11, s11, 163440
  v_mov_b32 v4, s11
  s_mov_b32 s12, 262144
isp_11:
  ds_read_b32 v5, v4
  s_sub_u32 s12, s12, 1
  s_waitcnt lgkmcnt(0)
  v_readfirstlane_b32 s11, v5
  s_nop 0
  s_cselect_b32 s61, -1, s11
  s_cmp_lt_u32 s61, 1
  s_cbranch_scc1 isp_11
  s_cmp_eq_u32 s11, 2
  s_cbranch_scc1 cond_12
back_13:
  s_lshl_b32 s62, s99, 6
  s_add_u32 s62, s62, 14745600
  s_load_dwordx8 s[16:23], s[48:49], s62
  s_waitcnt vmcnt(40)
  s_add_u32 m0, s13, 49152
  s_add_u32 s11, s50, 22528
  buffer_load_dwordx4 v60, s[64:67], s11 offen sc1 lds
  s_waitcnt vmcnt(40)
  s_add_u32 m0, s13, 50176
  s_add_u32 s11, s52, 22528
  buffer_load_dwordx4 v60, s[64:67], s11 offen sc1 lds
  s_waitcnt vmcnt(40)
  s_add_u32 m0, s13, 57344
  s_add_u32 s11, s50, 23552
  buffer_load_dwordx4 v60, s[64:67], s11 offen sc1 lds
  s_waitcnt vmcnt(40)
  s_add_u32 m0, s13, 58368
  s_add_u32 s11, s52, 23552
  buffer_load_dwordx4 v60, s[64:67], s11 offen sc1 lds
  s_waitcnt lgkmcnt(0)
  s_mov_b32 s60, s10
  s_mov_b32 s61, s10
  s_mov_b32 s23, s10
  s_xor_b64 s[16:17], s[16:17], s[60:61]
  s_xor_b64 s[18:19], s[18:19], s[60:61]
  s_or_b64 s[16:17], s[16:17], s[18:19]
  s_xor_b64 s[20:21], s[20:21], s[60:61]
  s_or_b64 s[16:17], s[16:17], s[20:21]
  s_xor_b64 s[22:23], s[22:23], s[60:61]
  s_or_b64 s[16:17], s[16:17], s[22:23]
  s_cbranch_scc1 slow_14
back_15:
  s_setprio 2
  v_add_u32 v4, s13, v60
  v_add_u32 v3, 0x10000, v4
  s_add_u32 s11, s51, 0
  buffer_load_dwordx4 v[12:15], v60, s[64:67], s11 offen sc1
  s_add_u32 s11, s53, 0
  buffer_load_dwordx4 v[16:19], v60, s[64:67], s11 offen sc1
  s_add_u32 s11, s51, 1024
  buffer_load_dwordx4 v[20:23], v60, s[64:67], s11 offen sc1
  s_add_u32 s11, s53, 1024
  buffer_load_dwordx4 v[24:27], v60, s[64:67], s11 offen sc1
  s_add_u32 s11, s51, 2048
  buffer_load_dwordx4 v[28:31], v60, s[64:67], s11 offen sc1
  s_add_u32 s11, s53, 2048
  buffer_load_dwordx4 v[32:35], v60, s[64:67], s11 offen sc1
  s_add_u32 s11, s51, 3072
  buffer_load_dwordx4 v[36:39], v60, s[64:67], s11 offen sc1
  s_add_u32 s11, s53, 3072
  buffer_load_dwordx4 v[40:43], v60, s[64:67], s11 offen sc1
  s_add_u32 s11, s51, 4096
  buffer_load_dwordx4 v[44:47], v60, s[64:67], s11 offen sc1
  s_add_u32 s11, s53, 4096
  buffer_load_dwordx4 v[48:51], v60, s[64:67], s11 offen sc1
  s_add_u32 s11, s51, 5120
  buffer_load_dwordx4 v[52:55], v60, s[64:67], s11 offen sc1
  s_add_u32 s11, s53, 5120
  buffer_load_dwordx4 v[56:59], v60, s[64:67], s11 offen sc1
  s_lshl_b32 s11, s3, 2
  s_add_u32 s11, s11, 163440
  v_mov_b32 v5, s11
  s_waitcnt vmcnt(11)
  v_mfma_f32_32x32x16_bf16 v[192:207], v[80:83], v[12:15], 0
  v_mfma_f32_32x32x16_bf16 v[224:239], v[84:87], v[12:15], 0
  s_add_u32 s11, s51, 6144
  buffer_load_dwordx4 v[12:15], v60, s[64:67], s11 offen sc1
  s_waitcnt vmcnt(11)
  v_mfma_f32_32x32x16_bf16 v[208:223], v[80:83], v[16:19], 0
  v_mfma_f32_32x32x16_bf16 v[240:255], v[84:87], v[16:19], 0
  s_add_u32 s11, s53, 6144
  buffer_load_dwordx4 v[16:19], v60, s[64:67], s11 offen sc1
  s_waitcnt vmcnt(11)
  v_mfma_f32_32x32x16_bf16 v[192:207], v[88:91], v[20:23], v[192:207]
  v_mfma_f32_32x32x16_bf16 v[224:239], v[92:95], v[20:23], v[224:239]
  s_add_u32 s11, s51, 7168
  buffer_load_dwordx4 v[20:23], v60, s[64:67], s11 offen sc1
  s_waitcnt vmcnt(11)
  v_mfma_f32_32x32x16_bf16 v[208:223], v[88:91], v[24:27], v[208:223]
  v_mfma_f32_32x32x16_bf16 v[240:255], v[92:95], v[24:27], v[240:255]
  s_add_u32 s11, s53, 7168
  buffer_load_dwordx4 v[24:27], v60, s[64:67], s11 offen sc1
  s_waitcnt vmcnt(11)
  v_mfma_f32_32x32x16_bf16 v[192:207], v[96:99], v[28:31], v[192:207]
  v_mfma_f32_32x32x16_bf16 v[224:239], v[100:103], v[28:31], v[224:239]
  s_add_u32 s11, s51, 8192
  buffer_load_dwordx4 v[28:31], v60, s[64:67], s11 offen sc1
  s_waitcnt vmcnt(11)
  v_mfma_f32_32x32x16_bf16 v[208:223], v[96:99], v[32:35], v[208:223]
  v_mfma_f32_32x32x16_bf16 v[240:255], v[100:103], v[32:35], v[240:255]
  s_add_u32 s11, s53, 8192
  buffer_load_dwordx4 v[32:35], v60, s[64:67], s11 offen sc1
  s_waitcnt vmcnt(11)
  v_mfma_f32_32x32x16_bf16 v[192:207], v[104:107], v[36:39], v[192:207]
  v_mfma_f32_32x32x16_bf16 v[224:239], v[108:111], v[36:39], v[224:239]
  s_add_u32 s11, s51, 9216
  buffer_load_dwordx4 v[36:39], v60, s[64:67], s11 offen sc1
  s_waitcnt vmcnt(11)
  v_mfma_f32_32x32x16_bf16 v[208:223], v[104:107], v[40:43], v[208:223]
  v_mfma_f32_32x32x16_bf16 v[240:255], v[108:111], v[40:43], v[240:255]
  s_add_u32 s11, s53, 9216
  buffer_load_dwordx4 v[40:43], v60, s[64:67], s11 offen sc1
  s_waitcnt vmcnt(11)
  v_mfma_f32_32x32x16_bf16 v[192:207], v[112:115], v[44:47], v[192:207]
  v_mfma_f32_32x32x16_bf16 v[224:239], v[116:119], v[44:47], v[224:239]
  s_add_u32 s11, s51, 10240
  buffer_load_dwordx4 v[44:47], v60, s[64:67], s11 offen sc1
  s_waitcnt vmcnt(11)
  v_mfma_f32_32x32x16_bf16 v[208:223], v[112:115], v[48:51], v[208:223]
  v_mfma_f32_32x32x16_bf16 v[240:255], v[116:119], v[48:51], v[240:255]
  s_add_u32 s11, s53, 10240
  buffer_load_dwordx4 v[48:51], v60, s[64:67], s11 offen sc1
  s_waitcnt vmcnt(11)
  v_mfma_f32_32x32x16_bf16 v[192:207], v[120:123], v[52:55], v[192:207]
  v_mfma_f32_32x32x16_bf16 v[224:239], v[124:127], v[52:55], v[224:239]
  s_add_u32 s11, s51, 11264
  buffer_load_dwordx4 v[52:55], v60, s[64:67], s11 offen sc1
  s_waitcnt vmcnt(11)
  v_mfma_f32_32x32x16_bf16 v[208:223], v[120:123], v[56:59], v[208:223]
  v_mfma_f32_32x32x16_bf16 v[240:255], v[124:127], v[56:59], v[240:255]
  s_add_u32 s11, s53, 11264
  buffer_load_dwordx4 v[56:59], v60, s[64:67], s11 offen sc1
  s_waitcnt vmcnt(11)
  v_mfma_f32_32x32x16_bf16 v[192:207], v[128:131], v[12:15], v[192:207]
  v_mfma_f32_32x32x16_bf16 v[224:239], v[132:135], v[12:15], v[224:239]
  s_add_u32 s11, s51, 12288
  buffer_load_dwordx4 v[12:15], v60, s[64:67], s11 offen sc1
  s_waitcnt vmcnt(11)
  v_mfma_f32_32x32x16_bf16 v[208:223], v[128:131], v[16:19], v[208:223]
  v_mfma_f32_32x32x16_bf16 v[240:255], v[132:135], v[16:19], v[240:255]
  s_add_u32 s11, s53, 12288
  buffer_load_dwordx4 v[16:19], v60, s[64:67], s11 offen sc1
  s_waitcnt vmcnt(11)
  v_mfma_f32_32x32x16_bf16 v[192:207], v[136:139], v[20:23], v[192:207]
  v_mfma_f32_32x32x16_bf16 v[224:239], v[140:143], v[20:23], v[224:239]
  s_add_u32 s11, s51, 13312
  buffer_load_dwordx4 v[20:23], v60, s[64:67], s11 offen sc1
  s_waitcnt vmcnt(11)
  v_mfma_f32_32x32x16_bf16 v[208:223], v[136:139], v[24:27], v[208:223]
  v_mfma_f32_32x32x16_bf16 v[240:255], v[140:143], v[24:27], v[240:255]
  s_add_u32 s11, s53, 13312
  buffer_load_dwordx4 v[24:27], v60, s[64:67], s11 offen sc1
  s_waitcnt vmcnt(11)
  v_mfma_f32_32x32x16_bf16 v[192:207], v[144:147], v[28:31], v[192:207]
  v_mfma_f32_32x32x16_bf16 v[224:239], v[148:151], v[28:31], v[224:239]
  s_add_u32 s11, s51, 14336
  buffer_load_dwordx4 v[28:31], v60, s[64:67], s11 offen sc1
  s_waitcnt vmcnt(11)
  v_mfma_f32_32x32x16_bf16 v[208:223], v[144:147], v[32:35], v[208:223]
  v_mfma_f32_32x32x16_bf16 v[240:255], v[148:151], v[32:35], v[240:255]
  s_add_u32 s11, s53, 14336
  buffer_load_dwordx4 v[32:35], v60, s[64:67], s11 offen sc1
  s_waitcnt vmcnt(11)
  v_mfma_f32_32x32x16_bf16 v[192:207], v[152:155], v[36:39], v[192:207]
  v_mfma_f32_32x32x16_bf16 v[224:239], v[156:159], v[36:39], v[224:239]
  s_add_u32 s11, s51, 15360
  buffer_load_dwordx4 v[36:39], v60, s[64:67], s11 offen sc1
  s_waitcnt vmcnt(11)
  v_mfma_f32_32x32x16_bf16 v[208:223], v[152:155], v[40:43], v[208:223]
  v_mfma_f32_32x32x16_bf16 v[240:255], v[156:159], v[40:43], v[240:255]
  s_add_u32 s11, s53, 15360
  buffer_load_dwordx4 v[40:43], v60, s[64:67], s11 offen sc1
  s_waitcnt vmcnt(11)
  v_mfma_f32_32x32x16_bf16 v[192:207], v[160:163], v[44:47], v[192:207]
  v_mfma_f32_32x32x16_bf16 v[224:239], v[164:167], v[44:47], v[224:239]
  s_add_u32 s11, s51, 16384
  buffer_load_dwordx4 v[44:47], v60, s[64:67], s11 offen sc1
  s_waitcnt vmcnt(11)
  v_mfma_f32_32x32x16_bf16 v[208:223], v[160:163], v[48:51], v[208:223]
  v_mfma_f32_32x32x16_bf16 v[240:255], v[164:167], v[48:51], v[240:255]
  s_add_u32 s11, s53, 16384
  buffer_load_dwordx4 v[48:51], v60, s[64:67], s11 offen sc1
  s_waitcnt vmcnt(11)
  v_mfma_f32_32x32x16_bf16 v[192:207], v[168:171], v[52:55], v[192:207]
  v_mfma_f32_32x32x16_bf16 v[224:239], v[172:175], v[52:55], v[224:239]
  s_add_u32 s11, s51, 17408
  buffer_load_dwordx4 v[52:55], v60, s[64:67], s11 offen sc1
  s_waitcnt vmcnt(11)
  v_mfma_f32_32x32x16_bf16 v[208:223], v[168:171], v[56:59], v[208:223]
  v_mfma_f32_32x32x16_bf16 v[240:255], v[172:175], v[56:59], v[240:255]
  s_add_u32 s11, s53, 17408
  buffer_load_dwordx4 v[56:59], v60, s[64:67], s11 offen sc1
  s_waitcnt vmcnt(11)
  v_mfma_f32_32x32x16_bf16 v[192:207], v[176:179], v[12:15], v[192:207]
  ds_read_b128 v[80:83], v4 offset:0
  v_mfma_f32_32x32x16_bf16 v[224:239], v[180:183], v[12:15], v[224:239]
  s_add_u32 s11, s51, 18432
  buffer_load_dwordx4 v[12:15], v60, s[64:67], s11 offen sc1
  s_waitcnt vmcnt(11)
  v_mfma_f32_32x32x16_bf16 v[208:223], v[176:179], v[16:19], v[208:223]
  ds_read_b128 v[84:87], v4 offset:1024
  v_mfma_f32_32x32x16_bf16 v[240:255], v[180:183], v[16:19], v[240:255]
  s_add_u32 s11, s53, 18432
  buffer_load_dwordx4 v[16:19], v60, s[64:67], s11 offen sc1
  s_waitcnt vmcnt(11)
  v_mfma_f32_32x32x16_bf16 v[192:207], v[184:187], v[20:23], v[192:207]
  ds_read_b128 v[88:91], v4 offset:8192
  v_mfma_f32_32x32x16_bf16 v[224:239], v[188:191], v[20:23], v[224:239]
  s_add_u32 s11, s51, 19456
  buffer_load_dwordx4 v[20:23], v60, s[64:67], s11 offen sc1
  s_waitcnt vmcnt(11)
  v_mfma_f32_32x32x16_bf16 v[208:223], v[184:187], v[24:27], v[208:223]
  ds_read_b128 v[92:95], v4 offset:9216
  v_mfma_f32_32x32x16_bf16 v[240:255], v[188:191], v[24:27], v[240:255]
  s_add_u32 s11, s53, 19456
  buffer_load_dwordx4 v[24:27], v60, s[64:67], s11 offen sc1
  s_waitcnt vmcnt(11)
  v_mfma_f32_32x32x16_bf16 v[192:207], v[64:67], v[28:31], v[192:207]
  ds_read_b128 v[96:99], v4 offset:16384
  v_mfma_f32_32x32x16_bf16 v[224:239], v[68:71], v[28:31], v[224:239]
  s_add_u32 s11, s51, 20480
  buffer_load_dwordx4 v[28:31], v60, s[64:67], s11 offen sc1
  s_waitcnt vmcnt(11)
  v_mfma_f32_32x32x16_bf16 v[208:223], v[64:67], v[32:35], v[208:223]
  ds_read_b128 v[100:103], v4 offset:17408
  v_mfma_f32_32x32x16_bf16 v[240:255], v[68:71], v[32:35], v[240:255]
  s_add_u32 s11, s53, 20480
  buffer_load_dwordx4 v[32:35], v60, s[64:67], s11 offen sc1
  s_waitcnt vmcnt(11)
  v_mfma_f32_32x32x16_bf16 v[192:207], v[72:75], v[36:39], v[192:207]
  ds_read_b128 v[104:107], v4 offset:24576
  v_mfma_f32_32x32x16_bf16 v[224:239], v[76:79], v[36:39], v[224:239]
  s_add_u32 s11, s51, 21504
  buffer_load_dwordx4 v[36:39], v60, s[64:67], s11 offen sc1
  s_waitcnt vmcnt(11)
  v_mfma_f32_32x32x16_bf16 v[208:223], v[72:75], v[40:43], v[208:223]
  ds_read_b128 v[108:111], v4 offset:25600
  v_mfma_f32_32x32x16_bf16 v[240:255], v[76:79], v[40:43], v[240:255]
  s_add_u32 s11, s53, 21504
  buffer_load_dwordx4 v[40:43], v60, s[64:67], s11 offen sc1
  s_waitcnt lgkmcnt(6)
  s_waitcnt vmcnt(11)
  v_mfma_f32_32x32x16_bf16 v[192:207], v[80:83], v[44:47], v[192:207]
  ds_read_b128 v[112:115], v4 offset:32768
  v_mfma_f32_32x32x16_bf16 v[224:239], v[84:87], v[44:47], v[224:239]
  s_add_u32 s11, s51, 22528
  buffer_load_dwordx4 v[44:47], v60, s[64:67], s11 offen sc1
  global_load_dwordx4 v[176:179], v1, s[14:15]
  global_load_dwordx4 v[180:183], v61, s[14:15]
  global_load_dwordx4 v[184:187], v2, s[42:43]
  s_waitcnt vmcnt(14)
  v_mfma_f32_32x32x16_bf16 v[208:223], v[80:83], v[48:51], v[208:223]
  ds_read_b128 v[116:119], v4 offset:33792
  v_mfma_f32_32x32x16_bf16 v[240:255], v[84:87], v[48:51], v[240:255]
  s_add_u32 s11, s53, 22528
  buffer_load_dwordx4 v[48:51], v60, s[64:67], s11 offen sc1
  s_waitcnt lgkmcnt(6)
  s_waitcnt vmcnt(14)
  v_mfma_f32_32x32x16_bf16 v[192:207], v[88:91], v[52:55], v[192:207]
  ds_read_b128 v[120:123], v4 offset:40960
  v_mfma_f32_32x32x16_bf16 v[224:239], v[92:95], v[52:55], v[224:239]
  s_add_u32 s11, s51, 23552
  buffer_load_dwordx4 v[52:55], v60, s[64:67], s11 offen sc1
  s_waitcnt vmcnt(14)
  v_mfma_f32_32x32x16_bf16 v[208:223], v[88:91], v[56:59], v[208:223]
  ds_read_b128 v[124:127], v4 offset:41984
  v_mfma_f32_32x32x16_bf16 v[240:255], v[92:95], v[56:59], v[240:255]
  s_add_u32 s11, s53, 23552
  buffer_load_dwordx4 v[56:59], v60, s[64:67], s11 offen sc1
  s_waitcnt lgkmcnt(6)
  s_waitcnt vmcnt(14)
  v_mfma_f32_32x32x16_bf16 v[192:207], v[96:99], v[12:15], v[192:207]
  ds_read_b128 v[128:131], v4 offset:49152
  v_mfma_f32_32x32x16_bf16 v[224:239], v[100:103], v[12:15], v[224:239]
  s_add_u32 s11, s51, 24576
  buffer_load_dwordx4 v[12:15], v60, s[64:67], s11 offen sc1
  s_waitcnt vmcnt(14)
  v_mfma_f32_32x32x16_bf16 v[208:223], v[96:99], v[16:19], v[208:223]
  ds_read_b128 v[132:135], v4 offset:50176
  v_mfma_f32_32x32x16_bf16 v[240:255], v[100:103], v[16:19], v[240:255]
  s_add_u32 s11, s53, 24576
  buffer_load_dwordx4 v[16:19], v60, s[64:67], s11 offen sc1
  s_waitcnt lgkmcnt(6)
  s_waitcnt vmcnt(14)
  v_mfma_f32_32x32x16_bf16 v[192:207], v[104:107], v[20:23], v[192:207]
  ds_read_b128 v[136:139], v4 offset:57344
  v_mfma_f32_32x32x16_bf16 v[224:239], v[108:111], v[20:23], v[224:239]
  s_add_u32 s11, s51, 25600
  buffer_load_dwordx4 v[20:23], v60, s[64:67], s11 offen sc1
  s_waitcnt vmcnt(14)
  v_mfma_f32_32x32x16_bf16 v[208:223], v[104:107], v[24:27], v[208:223]
  ds_read_b128 v[140:143], v4 offset:58368
  v_mfma_f32_32x32x16_bf16 v[240:255], v[108:111], v[24:27], v[240:255]
  s_add_u32 s11, s53, 25600
  buffer_load_dwordx4 v[24:27], v60, s[64:67], s11 offen sc1
  s_lshl_b32 s11, s3, 2
  s_add_u32 s11, s11, 163472
  v_mov_b32 v6, s11
  v_mov_b32 v7, 3
  ds_write_b32 v6, v7
  s_waitcnt lgkmcnt(7)
  s_waitcnt vmcnt(14)
  v_mfma_f32_32x32x16_bf16 v[192:207], v[112:115], v[28:31], v[192:207]
  ds_read_b128 v[144:147], v3 offset:0
  v_mfma_f32_32x32x16_bf16 v[224:239], v[116:119], v[28:31], v[224:239]
  s_add_u32 s11, s51, 26624
  buffer_load_dwordx4 v[28:31], v60, s[64:67], s11 offen sc1
  s_waitcnt vmcnt(14)
  v_mfma_f32_32x32x16_bf16 v[208:223], v[112:115], v[32:35], v[208:223]
  ds_read_b128 v[148:151], v3 offset:1024
  v_mfma_f32_32x32x16_bf16 v[240:255], v[116:119], v[32:35], v[240:255]
  s_add_u32 s11, s53, 26624
  buffer_load_dwordx4 v[32:35], v60, s[64:67], s11 offen sc1
  s_waitcnt lgkmcnt(7)
  s_waitcnt vmcnt(14)
  v_mfma_f32_32x32x16_bf16 v[192:207], v[120:123], v[36:39], v[192:207]
  ds_read_b128 v[152:155], v3 offset:8192
  v_mfma_f32_32x32x16_bf16 v[224:239], v[124:127], v[36:39], v[224:239]
  s_add_u32 s11, s51, 27648
  buffer_load_dwordx4 v[36:39], v60, s[64:67], s11 offen sc1
  s_waitcnt vmcnt(14)
  v_mfma_f32_32x32x16_bf16 v[208:223], v[120:123], v[40:43], v[208:223]
  ds_read_b128 v[156:159], v3 offset:9216
  v_mfma_f32_32x32x16_bf16 v[240:255], v[124:127], v[40:43], v[240:255]
  s_add_u32 s11, s53, 27648
  buffer_load_dwordx4 v[40:43], v60, s[64:67], s11 offen sc1
  s_waitcnt lgkmcnt(7)
  s_waitcnt vmcnt(14)
  v_mfma_f32_32x32x16_bf16 v[192:207], v[128:131], v[44:47], v[192:207]
  ds_read_b128 v[160:163], v3 offset:16384
  v_mfma_f32_32x32x16_bf16 v[224:239], v[132:135], v[44:47], v[224:239]
  s_waitcnt vmcnt(10)
  v_mfma_f32_32x32x16_bf16 v[208:223], v[128:131], v[48:51], v[208:223]
  ds_read_b128 v[164:167], v3 offset:17408
  v_mfma_f32_32x32x16_bf16 v[240:255], v[132:135], v[48:51], v[240:255]
  s_waitcnt lgkmcnt(7)
  s_waitcnt vmcnt(9)
  v_mfma_f32_32x32x16_bf16 v[192:207], v[136:139], v[52:55], v[192:207]
  ds_read_b128 v[168:171], v3 offset:24576
  v_mfma_f32_32x32x16_bf16 v[224:239], v[140:143], v[52:55], v[224:239]
  s_waitcnt vmcnt(8)
  v_mfma_f32_32x32x16_bf16 v[208:223], v[136:139], v[56:59], v[208:223]
  ds_read_b128 v[172:175], v3 offset:25600
  v_mfma_f32_32x32x16_bf16 v[240:255], v[140:143], v[56:59], v[240:255]
  s_waitcnt lgkmcnt(6)
  s_waitcnt vmcnt(7)
  v_mfma_f32_32x32x16_bf16 v[192:207], v[144:147], v[12:15], v[192:207]
  s_xor_b32 s11, s3, 1
  s_lshl_b32 s11, s11, 11
  v_add_u32 v5, s11, v60
  s_xor_b32 s11, s3, 2
  s_lshl_b32 s11, s11, 11
  v_add_u32 v6, s11, v60
  s_xor_b32 s11, s3, 3
  s_lshl_b32 s11, s11, 11
  v_add_u32 v7, s11, v60
  v_mfma_f32_32x32x16_bf16 v[224:239], v[148:151], v[12:15], v[224:239]
  s_lshl_b32 s12, s3, 12
  s_add_u32 s11, s12, 116736
  v_add_u32 v8, s11, v60
  s_and_b32 s11, s3, 1
  s_mul_i32 s11, s11, 8704
  s_lshr_b32 s12, s3, 1
  s_lshl_b32 s12, s12, 7
  s_add_u32 s12, s12, s11
  s_add_u32 s12, s12, 98304
  s_waitcnt vmcnt(6)
  v_mfma_f32_32x32x16_bf16 v[208:223], v[144:147], v[16:19], v[208:223]
  v_and_b32 v9, 31, v0
  v_mul_u32_u24 v9, 272, v9
  v_lshrrev_b32 v10, 5, v0
  v_lshl_add_u32 v9, v10, 4, v9
  v_add_u32 v9, s12, v9
  v_mfma_f32_32x32x16_bf16 v[240:255], v[148:151], v[16:19], v[240:255]
  s_mul_i32 s12, s3, 4352
  s_add_u32 s12, s12, 98304
  v_lshrrev_b32 v10, 3, v0
  v_mul_u32_u24 v10, 272, v10
  v_and_b32 v11, 7, v0
  v_lshl_add_u32 v10, v11, 5, v10
  v_add_u32 v10, s12, v10
  s_waitcnt lgkmcnt(4)
  s_waitcnt vmcnt(5)
  v_mfma_f32_32x32x16_bf16 v[192:207], v[152:155], v[20:23], v[192:207]
  v_lshlrev_b32 v64, 16, v176
  v_lshlrev_b32 v11, 16, v184
  v_add_f32 v64, v64, v11
  v_and_b32 v65, 0xffff0000, v176
  v_and_b32 v11, 0xffff0000, v184
  v_add_f32 v65, v65, v11
  v_mfma_f32_32x32x16_bf16 v[224:239], v[156:159], v[20:23], v[224:239]
  v_lshlrev_b32 v66, 16, v177
  v_lshlrev_b32 v11, 16, v185
  v_add_f32 v66, v66, v11
  v_and_b32 v67, 0xffff0000, v177
  v_and_b32 v11, 0xffff0000, v185
  v_add_f32 v67, v67, v11
  s_waitcnt vmcnt(4)
  v_mfma_f32_32x32x16_bf16 v[208:223], v[152:155], v[24:27], v[208:223]
  v_lshlrev_b32 v68, 16, v178
  v_lshlrev_b32 v11, 16, v186
  v_add_f32 v68, v68, v11
  v_and_b32 v69, 0xffff0000, v178
  v_and_b32 v11, 0xffff0000, v186
  v_add_f32 v69, v69, v11
  v_mfma_f32_32x32x16_bf16 v[240:255], v[156:159], v[24:27], v[240:255]
  v_lshlrev_b32 v70, 16, v179
  v_lshlrev_b32 v11, 16, v187
  v_add_f32 v70, v70, v11
  v_and_b32 v71, 0xffff0000, v179
  v_and_b32 v11, 0xffff0000, v187
  v_add_f32 v71, v71, v11
  s_waitcnt lgkmcnt(2)
  s_waitcnt vmcnt(3)
  v_mfma_f32_32x32x16_bf16 v[192:207], v[160:163], v[28:31], v[192:207]
  v_lshlrev_b32 v72, 16, v180
  v_lshlrev_b32 v11, 16, v184
  v_add_f32 v72, v72, v11
  v_and_b32 v73, 0xffff0000, v180
  v_and_b32 v11, 0xffff0000, v184
  v_add_f32 v73, v73, v11
  v_mfma_f32_32x32x16_bf16 v[224:239], v[164:167], v[28:31], v[224:239]
  v_lshlrev_b32 v74, 16, v181
  v_lshlrev_b32 v11, 16, v185
  v_add_f32 v74, v74, v11
  v_and_b32 v75, 0xffff0000, v181
  v_and_b32 v11, 0xffff0000, v185
  v_add_f32 v75, v75, v11
  s_waitcnt vmcnt(2)
  v_mfma_f32_32x32x16_bf16 v[208:223], v[160:163], v[32:35], v[208:223]
  v_lshlrev_b32 v76, 16, v182
  v_lshlrev_b32 v11, 16, v186
  v_add_f32 v76, v76, v11
  v_and_b32 v77, 0xffff0000, v182
  v_and_b32 v11, 0xffff0000, v186
  v_add_f32 v77, v77, v11
  v_mfma_f32_32x32x16_bf16 v[240:255], v[164:167], v[32:35], v[240:255]
  v_lshlrev_b32 v78, 16, v183
  v_lshlrev_b32 v11, 16, v187
  v_add_f32 v78, v78, v11
  v_and_b32 v79, 0xffff0000, v183
  v_and_b32 v11, 0xffff0000, v187
  v_add_f32 v79, v79, v11
  s_waitcnt lgkmcnt(0)
  s_waitcnt vmcnt(0)
  v_mfma_f32_32x32x16_bf16 v[240:255], v[172:175], v[40:43], v[240:255]
  v_mfma_f32_32x32x16_bf16 v[208:223], v[168:171], v[40:43], v[208:223]
  v_mfma_f32_32x32x16_bf16 v[224:239], v[172:175], v[36:39], v[224:239]
  v_mfma_f32_32x32x16_bf16 v[192:207], v[168:171], v[36:39], v[192:207]
  s_nop 8
  ds_write_b128 v4, v[240:243] offset:49152
  ds_write_b128 v4, v[244:247] offset:50176
  ds_write_b128 v4, v[248:251] offset:57344
  ds_write_b128 v4, v[252:255] offset:58368
  ds_write_b128 v4, v[208:211] offset:16384
  ds_write_b128 v4, v[212:215] offset:17408
  ds_write_b128 v4, v[216:219] offset:24576
  ds_write_b128 v4, v[220:223] offset:25600
  ds_write_b128 v4, v[224:227] offset:32768
  ds_write_b128 v4, v[228:231] offset:33792
  ds_write_b128 v4, v[232:235] offset:40960
  ds_write_b128 v4, v[236:239] offset:41984
  s_waitcnt lgkmcnt(0)
  s_barrier
  ds_read_b128 v[80:83], v5 offset:16384
  ds_read_b128 v[84:87], v5 offset:17408
  ds_read_b128 v[88:91], v5 offset:24576
  ds_read_b128 v[92:95], v5 offset:25600
  ds_read_b128 v[96:99], v6 offset:32768
  ds_read_b128 v[100:103], v6 offset:33792
  ds_read_b128 v[104:107], v6 offset:40960
  ds_read_b128 v[108:111], v6 offset:41984
  ds_read_b128 v[112:115], v7 offset:49152
  ds_read_b128 v[116:119], v7 offset:50176
  ds_read_b128 v[120:123], v7 offset:57344
  ds_read_b128 v[124:127], v7 offset:58368
  ds_read_b128 v[128:131], v8 offset:0
  ds_read_b128 v[132:135], v8 offset:1024
  ds_read_b128 v[136:139], v8 offset:2048
  ds_read_b128 v[140:143], v8 offset:3072
  s_waitcnt lgkmcnt(12)
  v_pk_add_f32 v[192:193], v[192:193], v[80:81]
  v_pk_add_f32 v[194:195], v[194:195], v[82:83]
  v_pk_add_f32 v[196:197], v[196:197], v[84:85]
  v_pk_add_f32 v[198:199], v[198:199], v[86:87]
  v_pk_add_f32 v[200:201], v[200:201], v[88:89]
  v_pk_add_f32 v[202:203], v[202:203], v[90:91]
  v_pk_add_f32 v[204:205], v[204:205], v[92:93]
  v_pk_add_f32 v[206:207], v[206:207], v[94:95]
  s_waitcnt lgkmcnt(8)
  v_pk_add_f32 v[192:193], v[192:193], v[96:97]
  v_pk_add_f32 v[194:195], v[194:195], v[98:99]
  v_pk_add_f32 v[196:197], v[196:197], v[100:101]
  v_pk_add_f32 v[198:199], v[198:199], v[102:103]
  v_pk_add_f32 v[200:201], v[200:201], v[104:105]
  v_pk_add_f32 v[202:203], v[202:203], v[106:107]
  v_pk_add_f32 v[204:205], v[204:205], v[108:109]
  v_pk_add_f32 v[206:207], v[206:207], v[110:111]
  s_waitcnt lgkmcnt(4)
  v_pk_add_f32 v[192:193], v[192:193], v[112:113]
  v_pk_add_f32 v[194:195], v[194:195], v[114:115]
  v_pk_add_f32 v[196:197], v[196:197], v[116:117]
  v_pk_add_f32 v[198:199], v[198:199], v[118:119]
  v_pk_add_f32 v[200:201], v[200:201], v[120:121]
  v_pk_add_f32 v[202:203], v[202:203], v[122:123]
  v_pk_add_f32 v[204:205], v[204:205], v[124:125]
  v_pk_add_f32 v[206:207], v[206:207], v[126:127]
  s_waitcnt lgkmcnt(0)
  v_pk_add_f32 v[192:193], v[192:193], v[128:129]
  v_pk_add_f32 v[194:195], v[194:195], v[130:131]
  v_pk_add_f32 v[196:197], v[196:197], v[132:133]
  v_pk_add_f32 v[198:199], v[198:199], v[134:135]
  v_pk_add_f32 v[200:201], v[200:201], v[136:137]
  v_pk_add_f32 v[202:203], v[202:203], v[138:139]
  v_pk_add_f32 v[204:205], v[204:205], v[140:141]
  v_pk_add_f32 v[206:207], v[206:207], v[142:143]
  ds_write_b128 v9, v[192:195] offset:0
  ds_write_b128 v9, v[196:199] offset:32
  ds_write_b128 v9, v[200:203] offset:64
  ds_write_b128 v9, v[204:207] offset:96
  s_waitcnt lgkmcnt(0)
  s_barrier
  ds_read_b128 v[16:19], v10 offset:0
  ds_read_b128 v[20:23], v10 offset:16
  ds_read_b128 v[24:27], v10 offset:2176
  ds_read_b128 v[28:31], v10 offset:2192
  s_waitcnt lgkmcnt(2)
  v_pk_add_f32 v[16:17], v[16:17], v[64:65]
  v_pk_add_f32 v[18:19], v[18:19], v[66:67]
  v_pk_add_f32 v[20:21], v[20:21], v[68:69]
  v_pk_add_f32 v[22:23], v[22:23], v[70:71]
  v_cvt_pk_bf16_f32 v48, v16, v17
  v_cvt_pk_bf16_f32 v49, v18, v19
  v_cvt_pk_bf16_f32 v50, v20, v21
  v_cvt_pk_bf16_f32 v51, v22, v23
  global_store_dwordx4 v1, v[48:51], s[44:45] sc1
  s_waitcnt lgkmcnt(0)
  v_pk_add_f32 v[24:25], v[24:25], v[72:73]
  v_pk_add_f32 v[26:27], v[26:27], v[74:75]
  v_pk_add_f32 v[28:29], v[28:29], v[76:77]
  v_pk_add_f32 v[30:31], v[30:31], v[78:79]
  v_cvt_pk_bf16_f32 v52, v24, v25
  v_cvt_pk_bf16_f32 v53, v26, v27
  v_cvt_pk_bf16_f32 v54, v28, v29
  v_cvt_pk_bf16_f32 v55, v30, v31
  global_store_dwordx4 v61, v[52:55], s[44:45] sc1
  s_endpgm
slow_1:
  s_nop 4
  s_sleep 6
  s_load_dword s10, s[92:93], 64
  s_waitcnt lgkmcnt(0)
  s_cmp_lg_u32 s10, 0
  s_cbranch_scc1 nonced_17
  s_mov_b32 s12, 65536
nonce_16:
  s_sleep 4
  global_load_dword v145, v147, s[92:93] offset:0 sc1
  s_waitcnt vmcnt(0)
  v_readfirstlane_b32 s10, v145
  s_nop 1
  s_cmp_lg_u32 s10, 0
  s_cbranch_scc1 nonced_17
  s_sub_u32 s12, s12, 1
  s_cbranch_scc0 nonce_16
nonced_17:
  s_nop 4
  s_branch back_2
slow_3:
  s_nop 4
  s_sleep 6
  s_load_dword s10, s[92:93], 192
  s_waitcnt lgkmcnt(0)
  s_cmp_lg_u32 s10, 0
  s_cbranch_scc1 nonced_19
  s_mov_b32 s12, 65536
nonce_18:
  s_sleep 4
  global_load_dword v145, v147, s[92:93] offset:128 sc1
  s_waitcnt vmcnt(0)
  v_readfirstlane_b32 s10, v145
  s_nop 1
  s_cmp_lg_u32 s10, 0
  s_cbranch_scc1 nonced_19
  s_sub_u32 s12, s12, 1
  s_cbranch_scc0 nonce_18
nonced_19:
  s_nop 4
  s_branch back_4
cond_5:
  s_nop 4
  s_lshl_b32 s11, s94, 6
  s_add_u32 s11, s11, 14745600
  v_lshlrev_b32 v180, 14, v0
  v_add_u32 v180, s11, v180
  v_mov_b32 v181, s10
  s_mov_b32 exec_hi, 0
  global_store_dword v180, v181, s[48:49] sc1
  s_mov_b64 exec, -1
  s_nop 4
  s_branch back_6
slow_8:
  s_nop 4
  s_lshl_b32 s62, s94, 6
  s_add_u32 s62, s62, 15024128
  s_mov_b32 s63, 15
sw_20:
  s_load_dword s60, s[48:49], s62
  s_waitcnt lgkmcnt(0)
  s_cmp_eq_u32 s60, s10
  s_cbranch_scc1 swd_21
  s_sleep 4
  s_add_u32 s62, s62, 16384
  s_sub_u32 s63, s63, 1
  s_cmp_lg_u32 s63, 0
  s_cbranch_scc1 sw_20
  s_sub_u32 s62, s62, 16384
  v_mov_b32 v4, s62
  s_mov_b32 s12, 65536
poll_22:
  global_load_dword v5, v4, s[48:49] sc1
  s_waitcnt vmcnt(0)
  v_cmp_ne_u32 vcc, s10, v5
  s_nop 0
  s_cmp_eq_u64 vcc, 0
  s_cbranch_scc1 polld_23
  s_sleep 4
  s_sub_u32 s12, s12, 1
  s_cbranch_scc0 poll_22
polld_23:
swd_21:
  s_nop 4
  s_branch back_9
cond_12:
  s_nop 4
  s_add_u32 m0, s13, 0
  s_add_u32 s11, s50, 16384
  buffer_load_dwordx4 v60, s[64:67], s11 offen sc1 lds
  s_add_u32 m0, s13, 1024
  s_add_u32 s11, s52, 16384
  buffer_load_dwordx4 v60, s[64:67], s11 offen sc1 lds
  s_add_u32 m0, s13, 8192
  s_add_u32 s11, s50, 17408
  buffer_load_dwordx4 v60, s[64:67], s11 offen sc1 lds
  s_add_u32 m0, s13, 9216
  s_add_u32 s11, s52, 17408
  buffer_load_dwordx4 v60, s[64:67], s11 offen sc1 lds
  s_add_u32 m0, s13, 16384
  s_add_u32 s11, s50, 18432
  buffer_load_dwordx4 v60, s[64:67], s11 offen sc1 lds
  s_add_u32 m0, s13, 17408
  s_add_u32 s11, s52, 18432
  buffer_load_dwordx4 v60, s[64:67], s11 offen sc1 lds
  s_nop 4
  s_branch back_13
slow_14:
  s_nop 4
  s_mov_b32 s63, 7
hr_24:
  s_add_u32 s62, s62, 16384
  s_load_dwordx8 s[16:23], s[48:49], s62
  s_waitcnt lgkmcnt(0)
  s_mov_b32 s60, s10
  s_mov_b32 s61, s10
  s_mov_b32 s23, s10
  s_xor_b64 s[16:17], s[16:17], s[60:61]
  s_xor_b64 s[18:19], s[18:19], s[60:61]
  s_or_b64 s[16:17], s[16:17], s[18:19]
  s_xor_b64 s[20:21], s[20:21], s[60:61]
  s_or_b64 s[16:17], s[16:17], s[20:21]
  s_xor_b64 s[22:23], s[22:23], s[60:61]
  s_or_b64 s[16:17], s[16:17], s[22:23]
  s_cbranch_scc0 hrd_25
  s_sleep 3
  s_sub_u32 s63, s63, 1
  s_cmp_lg_u32 s63, 0
  s_cbranch_scc1 hr_24
  v_min_u32 v4, 6, v0
  v_lshlrev_b32 v4, 2, v4
  v_add_u32 v4, s62, v4
  s_mov_b32 s12, 65536
poll_26:
  global_load_dword v5, v4, s[48:49] sc1
  s_waitcnt vmcnt(0)
  v_cmp_ne_u32 vcc, s10, v5
  s_nop 0
  s_cmp_eq_u64 vcc, 0
  s_cbranch_scc1 polld_27
  s_sleep 16
  s_sub_u32 s12, s12, 1
  s_cbranch_scc0 poll_26
polld_27:
hrd_25:
  s_nop 4
  s_branch back_15
L_AUX:
  s_sub_u32 s68, s3, 4
  s_lshr_b32 s69, s68, 1
  s_and_b32 s98, s68, 1
  s_lshl_b32 s99, s4, 6
  s_lshl_b32 s11, s5, 1
  s_add_u32 s99, s99, s11
  s_add_u32 s99, s99, s69
  v_mov_b32 v47, 0
  v_lshlrev_b32 v46, 4, v0
  s_cmp_ge_u32 s5, 28
  s_cbranch_scc1 L_XA
  s_setprio 3
  v_lshrrev_b32 v4, 3, v0
  v_lshrrev_b32 v5, 4, v0
  v_and_b32 v6, 7, v0
  v_xor_b32 v6, v6, v5
  v_lshlrev_b32 v6, 4, v6
  v_lshl_add_u32 v1, v4, 10, v6
  v_xor_b32 v2, 64, v1
  v_and_b32 v6, 15, v0
  v_lshlrev_b32 v7, 2, v5
  v_xor_b32 v6, v6, v7
  v_lshlrev_b32 v6, 4, v6
  v_mul_u32_u24 v3, 3584, v5
  v_add_u32 v3, v3, v6
  s_lshl_b32 s13, s6, 17
  s_lshl_b32 s11, s68, 15
  s_add_u32 s13, s13, s11
  s_lshl_b32 s14, s7, 8
  s_mul_i32 s11, s68, 57344
  s_add_u32 s14, s14, s11
  s_lshl_b32 s15, s68, 12
  v_lshlrev_b32 v23, 2, v0
  v_add_u32 v23, 163392, v23
  ds_write_b32 v23, v47
  v_mov_b32 v23, 141062
  ds_write_b16 v23, v47
  ds_write_b16 v23, v47 offset:2832
  s_mul_i32 s11, s68, 4352
  s_add_u32 s11, s11, 143936
  v_lshlrev_b32 v106, 2, v0
  v_add_u32 v118, s11, v106
  v_add_u32 v119, 1088, v118
  v_add_u32 v120, 2176, v118
  v_add_u32 v121, 3264, v118
  v_and_b32 v106, 15, v0
  v_mul_u32_u24 v106, 272, v106
  v_lshrrev_b32 v107, 4, v0
  v_lshl_add_u32 v106, v107, 4, v106
  v_add_u32 v122, s11, v106
  v_lshlrev_b32 v106, 4, v0
  v_add_u32 v123, s11, v106
  s_lshl_b32 s11, s99, 8
  s_lshl_b32 s12, s98, 7
  s_add_u32 s11, s11, s12
  v_lshlrev_b32 v106, 1, v0
  v_add_u32 v106, s11, v106
  s_lshl_b32 s11, s99, 1
  v_mov_b32 v107, s11
  s_waitcnt lgkmcnt(0)
  s_mov_b32 s52, s16
  s_and_b32 s53, s17, 0xffff
  s_mov_b32 s54, 2097152
  s_mov_b32 s55, 0x00020000
  s_mov_b32 s56, s36
  s_and_b32 s57, s37, 0xffff
  s_mov_b32 s58, 1835008
  s_mov_b32 s59, 0x00020000
  s_add_u32 s11, s97, 0
  s_and_b32 s11, s11, 7
  s_lshl_b32 s34, s11, 7
  s_add_u32 s34, s34, s13
  s_mul_i32 s35, s11, 229376
  s_add_u32 s35, s35, s14
  s_add_u32 m0, s15, 0
  s_add_u32 s11, s34, 0
  buffer_load_dwordx4 v1, s[52:55], s11 offen lds
  s_add_u32 m0, s15, 16384
  s_add_u32 s11, s35, 0
  buffer_load_dwordx4 v3, s[56:59], s11 offen lds
  s_add_u32 m0, s15, 1024
  s_add_u32 s11, s34, 8192
  buffer_load_dwordx4 v2, s[52:55], s11 offen lds
  s_add_u32 m0, s15, 17408
  s_add_u32 s11, s35, 14336
  buffer_load_dwordx4 v3, s[56:59], s11 offen lds
  s_add_u32 m0, s15, 2048
  s_add_u32 s11, s34, 16384
  buffer_load_dwordx4 v1, s[52:55], s11 offen lds
  s_add_u32 m0, s15, 18432
  s_add_u32 s11, s35, 28672
  buffer_load_dwordx4 v3, s[56:59], s11 offen lds
  s_add_u32 m0, s15, 3072
  s_add_u32 s11, s34, 24576
  buffer_load_dwordx4 v2, s[52:55], s11 offen lds
  s_add_u32 m0, s15, 19456
  s_add_u32 s11, s35, 43008
  buffer_load_dwordx4 v3, s[56:59], s11 offen lds
  global_load_ushort v96, v106, s[18:19]
  global_load_ushort v97, v106, s[20:21]
  global_load_ushort v98, v106, s[22:23]
  global_load_ushort v99, v106, s[24:25]
  global_load_ushort v100, v106, s[26:27]
  global_load_ushort v101, v106, s[28:29]
  global_load_ushort v102, v107, s[30:31]
  s_lshl_b32 s11, s7, 8
  s_lshl_b32 s12, s68, 6
  s_add_u32 s11, s11, s12
  v_and_b32 v24, 15, v0
  v_lshlrev_b32 v25, 2, v24
  v_add_u32 v25, s11, v25
  global_load_dword v42, v25, s[38:39]
  s_lshl_b32 s11, s99, 1
  v_mov_b32 v18, s11
  global_load_ushort v217, v18, s[32:33]
  s_and_b32 s11, s68, 1
  s_lshl_b32 s11, s11, 6
  s_lshl_b32 s12, s8, 7
  s_add_u32 s11, s11, s12
  v_and_b32 v26, 3, v0
  v_lshlrev_b32 v26, 4, v26
  v_add_u32 v26, s11, v26
  s_lshr_b32 s11, s68, 1
  s_lshl_b32 s11, s11, 5
  s_lshl_b32 s12, s9, 6
  s_add_u32 s11, s11, s12
  v_lshrrev_b32 v27, 2, v0
  v_add_u32 v27, s11, v27
  v_lshl_add_u32 v216, v27, 12, v26
  s_mov_b32 s64, s48
  s_and_b32 s65, s49, 0xffff
  s_mov_b32 s66, 268435456
  s_mov_b32 s67, 0x00020000
  s_mov_b32 s92, s46
  s_mov_b32 s93, s47
  s_mul_i32 s11, s68, 4352
  s_lshl_b32 s12, s98, 11
  s_add_u32 s11, s11, s12
  s_add_u32 s11, s11, 143936
  v_add_u32 v246, s11, v46
  s_xor_b32 s11, s68, 1
  s_mul_i32 s11, s11, 4352
  s_add_u32 s11, s11, s12
  s_add_u32 s11, s11, 143936
  v_add_u32 v247, s11, v46
  s_lshl_b32 s11, s68, 2
  s_add_u32 s11, s11, 163424
  v_mov_b32 v188, s11
  v_xor_b32 v189, 4, v188
  v_and_b32 v18, 15, v0
  v_lshlrev_b32 v19, 1, v18
  v_add_u32 v19, 240, v19
  v_bfe_u32 v20, v18, 1, 1
  v_lshlrev_b32 v20, 8, v20
  v_and_b32 v21, 1, v18
  v_lshl_add_u32 v20, v21, 2, v20
  v_add_u32 v20, 512, v20
  v_cmp_gt_u32 vcc, 8, v18
  s_nop 1
  v_cndmask_b32 v19, v19, v18, vcc
  v_cmp_lt_u32 vcc, 11, v18
  s_nop 1
  v_cndmask_b32 v19, v19, v20, vcc
  v_lshlrev_b32 v20, 8, v18
  v_add_u32 v20, 1024, v20
  v_lshrrev_b32 v21, 4, v0
  v_lshlrev_b32 v21, 5, v21
  s_lshl_b32 s11, s98, 7
  v_add_u32 v21, s11, v21
  v_add_u32 v19, v19, v21
  v_add_u32 v20, v20, v21
  s_mul_i32 s11, s69, 2832
  s_add_u32 s11, s11, 105730
  v_mov_b32 v22, s11
  v_mov_b32 v23, 17665
  s_mov_b32 s12, 16255
  v_lshlrev_b32 v25, 2, v0
  v_add_u32 v25, 163584, v25
  v_add_u32 v24, 0, v19
  v_cvt_f32_u32 v24, v24
  v_add_u32 v24, 0xffff, v24
  v_lshrrev_b32 v24, 16, v24
  v_med3_u32 v24, v24, s12, v23
  v_lshl_add_u32 v220, v24, 1, v22
  v_add_u32 v24, 8, v19
  v_cvt_f32_u32 v24, v24
  v_add_u32 v24, 0xffff, v24
  v_lshrrev_b32 v24, 16, v24
  v_med3_u32 v24, v24, s12, v23
  v_lshl_add_u32 v221, v24, 1, v22
  v_add_u32 v24, 16, v19
  v_cvt_f32_u32 v24, v24
  v_add_u32 v24, 0xffff, v24
  v_lshrrev_b32 v24, 16, v24
  v_med3_u32 v24, v24, s12, v23
  v_lshl_add_u32 v222, v24, 1, v22
  v_add_u32 v24, 24, v19
  v_cvt_f32_u32 v24, v24
  v_add_u32 v24, 0xffff, v24
  v_lshrrev_b32 v24, 16, v24
  v_med3_u32 v24, v24, s12, v23
  v_lshl_add_u32 v223, v24, 1, v22
  v_add_u32 v24, 0, v20
  v_cvt_f32_u32 v24, v24
  v_add_u32 v24, 0xffff, v24
  v_lshrrev_b32 v24, 16, v24
  v_med3_u32 v24, v24, s12, v23
  v_lshl_add_u32 v224, v24, 1, v22
  v_cmp_eq_u32 vcc, v24, v23
  s_nop 1
  v_cndmask_b32 v224, v224, v25, vcc
  v_add_u32 v24, 8, v20
  v_cvt_f32_u32 v24, v24
  v_add_u32 v24, 0xffff, v24
  v_lshrrev_b32 v24, 16, v24
  v_med3_u32 v24, v24, s12, v23
  v_lshl_add_u32 v225, v24, 1, v22
  v_cmp_eq_u32 vcc, v24, v23
  s_nop 1
  v_cndmask_b32 v225, v225, v25, vcc
  v_add_u32 v24, 16, v20
  v_cvt_f32_u32 v24, v24
  v_add_u32 v24, 0xffff, v24
  v_lshrrev_b32 v24, 16, v24
  v_med3_u32 v24, v24, s12, v23
  v_lshl_add_u32 v226, v24, 1, v22
  v_cmp_eq_u32 vcc, v24, v23
  s_nop 1
  v_cndmask_b32 v226, v226, v25, vcc
  v_add_u32 v24, 24, v20
  v_cvt_f32_u32 v24, v24
  v_add_u32 v24, 0xffff, v24
  v_lshrrev_b32 v24, 16, v24
  v_med3_u32 v24, v24, s12, v23
  v_lshl_add_u32 v227, v24, 1, v22
  v_cmp_eq_u32 vcc, v24, v23
  s_nop 1
  v_cndmask_b32 v227, v227, v25, vcc
  s_lshl_b32 s11, s98, 10
  v_add_u32 v18, s11, v46
  v_sub_u32 v19, 2047, v18
  v_cvt_f32_i32 v19, v19
  v_mov_b32 v23, 17666
  v_subrev_f32 v20, 0x00000000, v19
  v_subrev_f32 v21, 0x3f800000, v19
  v_cvt_pk_bf16_f32 v20, v20, v21
  v_and_b32 v21, 0xffff, v20
  v_med3_u32 v21, v21, s12, v23
  v_lshl_add_u32 v228, v21, 1, v22
  v_lshrrev_b32 v20, 16, v20
  v_med3_u32 v20, v20, s12, v23
  v_lshl_add_u32 v229, v20, 1, v22
  v_subrev_f32 v20, 0x40000000, v19
  v_subrev_f32 v21, 0x40400000, v19
  v_cvt_pk_bf16_f32 v20, v20, v21
  v_and_b32 v21, 0xffff, v20
  v_med3_u32 v21, v21, s12, v23
  v_lshl_add_u32 v230, v21, 1, v22
  v_lshrrev_b32 v20, 16, v20
  v_med3_u32 v20, v20, s12, v23
  v_lshl_add_u32 v231, v20, 1, v22
  v_subrev_f32 v20, 0x40800000, v19
  v_subrev_f32 v21, 0x40a00000, v19
  v_cvt_pk_bf16_f32 v20, v20, v21
  v_and_b32 v21, 0xffff, v20
  v_med3_u32 v21, v21, s12, v23
  v_lshl_add_u32 v232, v21, 1, v22
  v_lshrrev_b32 v20, 16, v20
  v_med3_u32 v20, v20, s12, v23
  v_lshl_add_u32 v233, v20, 1, v22
  v_subrev_f32 v20, 0x40c00000, v19
  v_subrev_f32 v21, 0x40e00000, v19
  v_cvt_pk_bf16_f32 v20, v20, v21
  v_and_b32 v21, 0xffff, v20
  v_med3_u32 v21, v21, s12, v23
  v_lshl_add_u32 v234, v21, 1, v22
  v_lshrrev_b32 v20, 16, v20
  v_med3_u32 v20, v20, s12, v23
  v_lshl_add_u32 v235, v20, 1, v22
  v_subrev_f32 v20, 0x41000000, v19
  v_subrev_f32 v21, 0x41100000, v19
  v_cvt_pk_bf16_f32 v20, v20, v21
  v_and_b32 v21, 0xffff, v20
  v_med3_u32 v21, v21, s12, v23
  v_lshl_add_u32 v236, v21, 1, v22
  v_lshrrev_b32 v20, 16, v20
  v_med3_u32 v20, v20, s12, v23
  v_lshl_add_u32 v237, v20, 1, v22
  v_subrev_f32 v20, 0x41200000, v19
  v_subrev_f32 v21, 0x41300000, v19
  v_cvt_pk_bf16_f32 v20, v20, v21
  v_and_b32 v21, 0xffff, v20
  v_med3_u32 v21, v21, s12, v23
  v_lshl_add_u32 v238, v21, 1, v22
  v_lshrrev_b32 v20, 16, v20
  v_med3_u32 v20, v20, s12, v23
  v_lshl_add_u32 v239, v20, 1, v22
  v_subrev_f32 v20, 0x41400000, v19
  v_subrev_f32 v21, 0x41500000, v19
  v_cvt_pk_bf16_f32 v20, v20, v21
  v_and_b32 v21, 0xffff, v20
  v_med3_u32 v21, v21, s12, v23
  v_lshl_add_u32 v240, v21, 1, v22
  v_lshrrev_b32 v20, 16, v20
  v_med3_u32 v20, v20, s12, v23
  v_lshl_add_u32 v241, v20, 1, v22
  v_subrev_f32 v20, 0x41600000, v19
  v_subrev_f32 v21, 0x41700000, v19
  v_cvt_pk_bf16_f32 v20, v20, v21
  v_and_b32 v21, 0xffff, v20
  v_med3_u32 v21, v21, s12, v23
  v_lshl_add_u32 v242, v21, 1, v22
  v_lshrrev_b32 v20, 16, v20
  v_med3_u32 v20, v20, s12, v23
  v_lshl_add_u32 v243, v20, 1, v22
  v_subrev_f32 v20, 0x41800000, v19
  v_subrev_f32 v21, 0x41880000, v19
  v_cvt_pk_bf16_f32 v20, v20, v21
  v_and_b32 v21, 0xffff, v20
  v_med3_u32 v21, v21, s12, v23
  v_lshl_add_u32 v244, v21, 1, v22
  s_mul_i32 s95, s69, 8704
  s_add_u32 s95, s95, 143936
  v_lshlrev_b32 v248, 1, v18
  v_add_u32 v248, s95, v248
  v_and_b32 v249, 7, v0
  v_lshlrev_b32 v249, 2, v249
  v_add_u32 v249, s95, v249
  s_add_u32 s11, s97, 2
  s_and_b32 s11, s11, 7
  s_lshl_b32 s34, s11, 7
  s_add_u32 s34, s34, s13
  s_mul_i32 s35, s11, 229376
  s_add_u32 s35, s35, s14
  s_add_u32 m0, s15, 32768
  s_add_u32 s11, s34, 0
  buffer_load_dwordx4 v1, s[52:55], s11 offen lds
  s_add_u32 m0, s15, 49152
  s_add_u32 s11, s35, 0
  buffer_load_dwordx4 v3, s[56:59], s11 offen lds
  s_add_u32 m0, s15, 33792
  s_add_u32 s11, s34, 8192
  buffer_load_dwordx4 v2, s[52:55], s11 offen lds
  s_add_u32 m0, s15, 50176
  s_add_u32 s11, s35, 14336
  buffer_load_dwordx4 v3, s[56:59], s11 offen lds
  s_add_u32 m0, s15, 34816
  s_add_u32 s11, s34, 16384
  buffer_load_dwordx4 v1, s[52:55], s11 offen lds
  s_add_u32 m0, s15, 51200
  s_add_u32 s11, s35, 28672
  buffer_load_dwordx4 v3, s[56:59], s11 offen lds
  s_add_u32 m0, s15, 35840
  s_add_u32 s11, s34, 24576
  buffer_load_dwordx4 v2, s[52:55], s11 offen lds
  s_add_u32 m0, s15, 52224
  s_add_u32 s11, s35, 43008
  buffer_load_dwordx4 v3, s[56:59], s11 offen lds
  s_waitcnt vmcnt(10)
  s_waitcnt lgkmcnt(0)
  s_barrier
  s_add_u32 s11, s97, 4
  s_and_b32 s11, s11, 7
  s_lshl_b32 s34, s11, 7
  s_add_u32 s34, s34, s13
  s_mul_i32 s35, s11, 229376
  s_add_u32 s35, s35, s14
  s_add_u32 m0, s15, 65536
  s_add_u32 s11, s34, 0
  buffer_load_dwordx4 v1, s[52:55], s11 offen lds
  s_add_u32 m0, s15, 81920
  s_add_u32 s11, s35, 0
  buffer_load_dwordx4 v3, s[56:59], s11 offen lds
  s_add_u32 m0, s15, 66560
  s_add_u32 s11, s34, 8192
  buffer_load_dwordx4 v2, s[52:55], s11 offen lds
  s_add_u32 m0, s15, 82944
  s_add_u32 s11, s35, 14336
  buffer_load_dwordx4 v3, s[56:59], s11 offen lds
  s_add_u32 m0, s15, 67584
  s_add_u32 s11, s34, 16384
  buffer_load_dwordx4 v1, s[52:55], s11 offen lds
  s_add_u32 m0, s15, 83968
  s_add_u32 s11, s35, 28672
  buffer_load_dwordx4 v3, s[56:59], s11 offen lds
  s_add_u32 m0, s15, 68608
  s_add_u32 s11, s34, 24576
  buffer_load_dwordx4 v2, s[52:55], s11 offen lds
  s_add_u32 m0, s15, 84992
  s_add_u32 s11, s35, 43008
  buffer_load_dwordx4 v3, s[56:59], s11 offen lds
  s_add_u32 s11, s97, 6
  s_and_b32 s11, s11, 7
  s_lshl_b32 s34, s11, 7
  s_add_u32 s34, s34, s13
  s_mul_i32 s35, s11, 229376
  s_add_u32 s35, s35, s14
  s_add_u32 m0, s15, 114688
  s_add_u32 s11, s35, 0
  buffer_load_dwordx4 v3, s[56:59], s11 offen lds
  s_add_u32 m0, s15, 115712
  s_add_u32 s11, s35, 14336
  buffer_load_dwordx4 v3, s[56:59], s11 offen lds
  s_add_u32 m0, s15, 116736
  s_add_u32 s11, s35, 28672
  buffer_load_dwordx4 v3, s[56:59], s11 offen lds
  s_add_u32 m0, s15, 117760
  s_add_u32 s11, s35, 43008
  buffer_load_dwordx4 v3, s[56:59], s11 offen lds
  s_waitcnt vmcnt(12)
  s_waitcnt lgkmcnt(0)
  s_barrier
  s_add_u32 s11, s97, 6
  s_and_b32 s11, s11, 7
  s_lshl_b32 s34, s11, 7
  s_add_u32 s34, s34, s13
  s_mul_i32 s35, s11, 229376
  s_add_u32 s35, s35, s14
  s_add_u32 m0, s15, 98304
  s_add_u32 s11, s34, 0
  buffer_load_dwordx4 v1, s[52:55], s11 offen lds
  s_add_u32 m0, s15, 99328
  s_add_u32 s11, s34, 8192
  buffer_load_dwordx4 v2, s[52:55], s11 offen lds
  s_add_u32 m0, s15, 100352
  s_add_u32 s11, s34, 16384
  buffer_load_dwordx4 v1, s[52:55], s11 offen lds
  s_add_u32 m0, s15, 101376
  s_add_u32 s11, s34, 24576
  buffer_load_dwordx4 v2, s[52:55], s11 offen lds
  v_lshlrev_b32 v96, 16, v96
  v_lshlrev_b32 v97, 16, v97
  v_lshlrev_b32 v98, 16, v98
  v_lshlrev_b32 v99, 16, v99
  v_lshlrev_b32 v100, 16, v100
  v_lshlrev_b32 v101, 16, v101
  v_lshlrev_b32 v102, 16, v102
  v_mul_f32 v102, 0x3fb8aa3b, v102
  v_exp_f32 v102, v102
  s_nop 0
  v_cvt_pk_bf16_f32 v102, v102, v102
  v_lshlrev_b32 v102, 16, v102
  v_mul_f32 v104, v102, v96
  v_mul_f32 v105, v102, v97
  v_mul_f32 v104, 0x3fb8aa3b, v104
  v_mul_f32 v105, 0x3e22f983, v105
  v_mul_f32 v98, v102, v98
  v_mul_f32 v99, v102, v99
  v_mul_f32 v106, v101, v99
  v_mul_f32 v107, v101, v98
  v_fma_f32 v96, v100, v98, -v106
  v_fma_f32 v97, v100, v99, v107
  v_sub_f32 v97, 0, v97
  v_mul_f32 v106, 0x3f800000, v104
  v_mul_f32 v107, 0x3f800000, v105
  v_exp_f32 v106, v106
  v_fract_f32 v107, v107
  v_cos_f32 v98, v107
  v_sin_f32 v99, v107
  v_mul_f32 v98, v106, v98
  v_mul_f32 v99, v106, v99
  v_mul_f32 v106, 0x43800000, v104
  v_mul_f32 v107, 0x43800000, v105
  v_exp_f32 v106, v106
  v_fract_f32 v107, v107
  v_cos_f32 v114, v107
  v_sin_f32 v115, v107
  v_mul_f32 v114, v106, v114
  v_mul_f32 v115, v106, v115
  v_mov_b32 v124, 0x3f80
  v_cvt_pk_bf16_f32 v125, v98, v99
  v_mul_f32 v106, v99, v99
  v_mul_f32 v107, v99, v98
  v_fma_f32 v100, v98, v98, -v106
  v_fma_f32 v101, v98, v99, v107
  v_cvt_pk_bf16_f32 v126, v100, v101
  v_mul_f32 v106, v101, v99
  v_mul_f32 v107, v101, v98
  v_fma_f32 v110, v100, v98, -v106
  v_fma_f32 v111, v100, v99, v107
  v_cvt_pk_bf16_f32 v127, v110, v111
  v_mul_f32 v106, v101, v101
  v_mul_f32 v107, v101, v100
  v_fma_f32 v102, v100, v100, -v106
  v_fma_f32 v103, v100, v101, v107
  v_cvt_pk_bf16_f32 v128, v102, v103
  v_mul_f32 v106, v103, v99
  v_mul_f32 v107, v103, v98
  v_fma_f32 v110, v102, v98, -v106
  v_fma_f32 v111, v102, v99, v107
  v_cvt_pk_bf16_f32 v129, v110, v111
  v_mul_f32 v106, v103, v101
  v_mul_f32 v107, v103, v100
  v_fma_f32 v108, v102, v100, -v106
  v_fma_f32 v109, v102, v101, v107
  v_cvt_pk_bf16_f32 v130, v108, v109
  v_mul_f32 v106, v109, v99
  v_mul_f32 v107, v109, v98
  v_fma_f32 v110, v108, v98, -v106
  v_fma_f32 v111, v108, v99, v107
  v_cvt_pk_bf16_f32 v131, v110, v111
  s_waitcnt vmcnt(8)
  s_waitcnt lgkmcnt(0)
  s_barrier
  s_load_dword s10, s[92:93], 128
  s_add_u32 s11, s97, 9
  s_and_b32 s11, s11, 7
  s_lshl_b32 s34, s11, 7
  s_add_u32 s34, s34, s13
  s_mul_i32 s35, s11, 229376
  s_add_u32 s35, s35, s14
  s_add_u32 m0, s15, 0
  s_add_u32 s11, s34, 0
  buffer_load_dwordx4 v1, s[52:55], s11 offen lds
  v_cvt_pk_bf16_f32 v132, v114, v115
  v_mul_f32 v106, v115, v101
  v_mul_f32 v107, v115, v100
  v_fma_f32 v110, v114, v100, -v106
  v_fma_f32 v111, v114, v101, v107
  v_cvt_pk_bf16_f32 v133, v110, v111
  v_mul_f32 v106, v115, v103
  s_add_u32 m0, s15, 16384
  s_add_u32 s11, s35, 0
  buffer_load_dwordx4 v3, s[56:59], s11 offen lds
  v_mul_f32 v107, v115, v102
  v_fma_f32 v110, v114, v102, -v106
  v_fma_f32 v111, v114, v103, v107
  v_cvt_pk_bf16_f32 v134, v110, v111
  v_mul_f32 v106, v115, v109
  v_mul_f32 v107, v115, v108
  v_fma_f32 v110, v114, v108, -v106
  s_add_u32 m0, s15, 1024
  s_add_u32 s11, s34, 8192
  buffer_load_dwordx4 v2, s[52:55], s11 offen lds
  v_fma_f32 v111, v114, v109, v107
  v_cvt_pk_bf16_f32 v135, v110, v111
  v_mul_f32 v106, v115, v115
  v_mul_f32 v107, v115, v114
  v_fma_f32 v116, v114, v114, -v106
  v_fma_f32 v117, v114, v115, v107
  v_cvt_pk_bf16_f32 v136, v116, v117
  s_add_u32 m0, s15, 17408
  s_add_u32 s11, s35, 14336
  buffer_load_dwordx4 v3, s[56:59], s11 offen lds
  v_mul_f32 v106, v117, v103
  v_mul_f32 v107, v117, v102
  v_fma_f32 v110, v116, v102, -v106
  v_fma_f32 v111, v116, v103, v107
  v_cvt_pk_bf16_f32 v137, v110, v111
  v_mul_f32 v106, v117, v115
  v_mul_f32 v107, v117, v114
  s_add_u32 m0, s15, 2048
  s_add_u32 s11, s34, 16384
  buffer_load_dwordx4 v1, s[52:55], s11 offen lds
  v_fma_f32 v112, v116, v114, -v106
  v_fma_f32 v113, v116, v115, v107
  v_cvt_pk_bf16_f32 v138, v112, v113
  v_mul_f32 v106, v113, v103
  v_mul_f32 v107, v113, v102
  v_fma_f32 v110, v112, v102, -v106
  v_fma_f32 v111, v112, v103, v107
  s_add_u32 m0, s15, 18432
  s_add_u32 s11, s35, 28672
  buffer_load_dwordx4 v3, s[56:59], s11 offen lds
  v_cvt_pk_bf16_f32 v139, v110, v111
  v_mul_f32 v106, v117, v117
  v_mul_f32 v107, v117, v116
  v_fma_f32 v110, v116, v116, -v106
  v_fma_f32 v111, v116, v117, v107
  v_cvt_pk_bf16_f32 v140, v110, v111
  v_mul_f32 v106, v111, v115
  s_add_u32 m0, s15, 3072
  s_add_u32 s11, s34, 24576
  buffer_load_dwordx4 v2, s[52:55], s11 offen lds
  v_mul_f32 v107, v111, v114
  v_fma_f32 v112, v110, v114, -v106
  v_fma_f32 v113, v110, v115, v107
  v_cvt_pk_bf16_f32 v141, v112, v113
  v_mul_f32 v106, v113, v115
  v_mul_f32 v107, v113, v114
  v_fma_f32 v110, v112, v114, -v106
  s_add_u32 m0, s15, 19456
  s_add_u32 s11, s35, 43008
  buffer_load_dwordx4 v3, s[56:59], s11 offen lds
  v_fma_f32 v111, v112, v115, v107
  v_cvt_pk_bf16_f32 v142, v110, v111
  v_mul_f32 v106, v111, v115
  v_mul_f32 v107, v111, v114
  v_fma_f32 v112, v110, v114, -v106
  v_fma_f32 v113, v110, v115, v107
  v_cvt_pk_bf16_f32 v143, v112, v113
  s_waitcnt lgkmcnt(0)
  s_cmp_eq_u32 s10, 0
  s_cbranch_scc1 slow_28
back_29:
  s_waitcnt vmcnt(8)
  s_waitcnt lgkmcnt(0)
  s_barrier
  s_add_u32 s11, s97, 11
  s_and_b32 s11, s11, 7
  s_lshl_b32 s34, s11, 7
  s_add_u32 s34, s34, s13
  s_mul_i32 s35, s11, 229376
  s_add_u32 s35, s35, s14
  s_add_u32 m0, s15, 32768
  s_add_u32 s11, s34, 0
  buffer_load_dwordx4 v1, s[52:55], s11 offen lds
  v_mul_f32 v106, v113, v115
  v_mul_f32 v107, v113, v114
  v_fma_f32 v110, v112, v114, -v106
  v_fma_f32 v111, v112, v115, v107
  v_cvt_pk_bf16_f32 v144, v110, v111
  v_mul_f32 v106, 0x41000000, v104
  v_mul_f32 v107, 0xc1000000, v105
  s_add_u32 m0, s15, 49152
  s_add_u32 s11, s35, 0
  buffer_load_dwordx4 v3, s[56:59], s11 offen lds
  v_exp_f32 v106, v106
  v_fract_f32 v107, v107
  v_cos_f32 v98, v107
  v_sin_f32 v99, v107
  v_mul_f32 v98, v106, v98
  v_mul_f32 v99, v106, v99
  v_cvt_pk_bf16_f32 v146, v96, v97
  s_add_u32 m0, s15, 33792
  s_add_u32 s11, s34, 8192
  buffer_load_dwordx4 v2, s[52:55], s11 offen lds
  v_mul_f32 v106, v97, v99
  v_mul_f32 v107, v97, v98
  v_fma_f32 v112, v96, v98, -v106
  v_fma_f32 v113, v96, v99, v107
  v_cvt_pk_bf16_f32 v147, v112, v113
  v_mul_f32 v106, v113, v99
  v_mul_f32 v107, v113, v98
  s_add_u32 m0, s15, 50176
  s_add_u32 s11, s35, 14336
  buffer_load_dwordx4 v3, s[56:59], s11 offen lds
  v_fma_f32 v110, v112, v98, -v106
  v_fma_f32 v111, v112, v99, v107
  v_cvt_pk_bf16_f32 v148, v110, v111
  v_mul_f32 v106, v111, v99
  v_mul_f32 v107, v111, v98
  v_fma_f32 v112, v110, v98, -v106
  v_fma_f32 v113, v110, v99, v107
  s_add_u32 m0, s15, 34816
  s_add_u32 s11, s34, 16384
  buffer_load_dwordx4 v1, s[52:55], s11 offen lds
  v_cvt_pk_bf16_f32 v149, v112, v113
  v_mul_f32 v106, v113, v99
  v_mul_f32 v107, v113, v98
  v_fma_f32 v110, v112, v98, -v106
  v_fma_f32 v111, v112, v99, v107
  v_cvt_pk_bf16_f32 v150, v110, v111
  v_mul_f32 v106, v111, v99
  s_add_u32 m0, s15, 51200
  s_add_u32 s11, s35, 28672
  buffer_load_dwordx4 v3, s[56:59], s11 offen lds
  v_mul_f32 v107, v111, v98
  v_fma_f32 v112, v110, v98, -v106
  v_fma_f32 v113, v110, v99, v107
  v_cvt_pk_bf16_f32 v151, v112, v113
  v_mul_f32 v106, v113, v99
  v_mul_f32 v107, v113, v98
  v_fma_f32 v110, v112, v98, -v106
  s_add_u32 m0, s15, 35840
  s_add_u32 s11, s34, 24576
  buffer_load_dwordx4 v2, s[52:55], s11 offen lds
  v_fma_f32 v111, v112, v99, v107
  v_cvt_pk_bf16_f32 v152, v110, v111
  v_mul_f32 v106, v111, v99
  v_mul_f32 v107, v111, v98
  v_fma_f32 v112, v110, v98, -v106
  v_fma_f32 v113, v110, v99, v107
  v_cvt_pk_bf16_f32 v153, v112, v113
  s_add_u32 m0, s15, 52224
  s_add_u32 s11, s35, 43008
  buffer_load_dwordx4 v3, s[56:59], s11 offen lds
  v_mul_f32 v106, v113, v99
  v_mul_f32 v107, v113, v98
  v_fma_f32 v110, v112, v98, -v106
  v_fma_f32 v111, v112, v99, v107
  v_cvt_pk_bf16_f32 v154, v110, v111
  v_mul_f32 v106, v111, v99
  v_mul_f32 v107, v111, v98
  s_waitcnt vmcnt(8)
  s_waitcnt lgkmcnt(0)
  s_barrier
  s_add_u32 s11, s97, 13
  s_and_b32 s11, s11, 7
  s_lshl_b32 s34, s11, 7
  s_add_u32 s34, s34, s13
  s_mul_i32 s35, s11, 229376
  s_add_u32 s35, s35, s14
  s_add_u32 m0, s15, 65536
  s_add_u32 s11, s34, 0
  buffer_load_dwordx4 v1, s[52:55], s11 offen lds
  v_fma_f32 v112, v110, v98, -v106
  v_fma_f32 v113, v110, v99, v107
  v_cvt_pk_bf16_f32 v155, v112, v113
  v_mul_f32 v106, v113, v99
  v_mul_f32 v107, v113, v98
  v_fma_f32 v110, v112, v98, -v106
  v_fma_f32 v111, v112, v99, v107
  s_add_u32 m0, s15, 81920
  s_add_u32 s11, s35, 0
  buffer_load_dwordx4 v3, s[56:59], s11 offen lds
  v_cvt_pk_bf16_f32 v156, v110, v111
  v_mul_f32 v106, v111, v99
  v_mul_f32 v107, v111, v98
  v_fma_f32 v112, v110, v98, -v106
  v_fma_f32 v113, v110, v99, v107
  v_cvt_pk_bf16_f32 v157, v112, v113
  v_mul_f32 v106, v113, v99
  s_add_u32 m0, s15, 66560
  s_add_u32 s11, s34, 8192
  buffer_load_dwordx4 v2, s[52:55], s11 offen lds
  v_mul_f32 v107, v113, v98
  v_fma_f32 v110, v112, v98, -v106
  v_fma_f32 v111, v112, v99, v107
  v_cvt_pk_bf16_f32 v158, v110, v111
  v_mul_f32 v106, v111, v99
  v_mul_f32 v107, v111, v98
  v_fma_f32 v112, v110, v98, -v106
  s_add_u32 m0, s15, 82944
  s_add_u32 s11, s35, 14336
  buffer_load_dwordx4 v3, s[56:59], s11 offen lds
  v_fma_f32 v113, v110, v99, v107
  v_cvt_pk_bf16_f32 v159, v112, v113
  v_mul_f32 v106, v113, v99
  v_mul_f32 v107, v113, v98
  v_fma_f32 v110, v112, v98, -v106
  v_fma_f32 v111, v112, v99, v107
  v_cvt_pk_bf16_f32 v160, v110, v111
  s_add_u32 m0, s15, 67584
  s_add_u32 s11, s34, 16384
  buffer_load_dwordx4 v1, s[52:55], s11 offen lds
  v_mul_f32 v106, v111, v99
  v_mul_f32 v107, v111, v98
  v_fma_f32 v112, v110, v98, -v106
  v_fma_f32 v113, v110, v99, v107
  v_cvt_pk_bf16_f32 v161, v112, v113
  v_mul_f32 v106, v113, v99
  v_mul_f32 v107, v113, v98
  s_add_u32 m0, s15, 83968
  s_add_u32 s11, s35, 28672
  buffer_load_dwordx4 v3, s[56:59], s11 offen lds
  v_fma_f32 v110, v112, v98, -v106
  v_fma_f32 v111, v112, v99, v107
  v_cvt_pk_bf16_f32 v162, v110, v111
  v_mul_f32 v106, v111, v99
  v_mul_f32 v107, v111, v98
  v_fma_f32 v112, v110, v98, -v106
  v_fma_f32 v113, v110, v99, v107
  s_add_u32 m0, s15, 68608
  s_add_u32 s11, s34, 24576
  buffer_load_dwordx4 v2, s[52:55], s11 offen lds
  v_cvt_pk_bf16_f32 v163, v112, v113
  v_mul_f32 v106, v113, v99
  v_mul_f32 v107, v113, v98
  v_fma_f32 v110, v112, v98, -v106
  v_fma_f32 v111, v112, v99, v107
  v_cvt_pk_bf16_f32 v164, v110, v111
  v_mul_f32 v106, v111, v99
  s_add_u32 m0, s15, 84992
  s_add_u32 s11, s35, 43008
  buffer_load_dwordx4 v3, s[56:59], s11 offen lds
  v_mul_f32 v107, v111, v98
  v_fma_f32 v112, v110, v98, -v106
  v_fma_f32 v113, v110, v99, v107
  v_cvt_pk_bf16_f32 v165, v112, v113
  v_mul_f32 v106, v113, v99
  v_mul_f32 v107, v113, v98
  v_fma_f32 v110, v112, v98, -v106
  s_lshl_b32 s11, s6, 10
  s_lshl_b32 s12, s68, 8
  s_add_u32 s11, s11, s12
  s_add_u32 s11, s11, 14680064
  v_and_b32 v40, 31, v0
  v_lshlrev_b32 v38, 3, v40
  v_add_u32 v40, s11, v38
  global_load_dwordx2 v[44:45], v40, s[48:49] sc1
  s_waitcnt vmcnt(9)
  s_waitcnt lgkmcnt(0)
  s_barrier
  s_add_u32 s11, s97, 15
  s_and_b32 s11, s11, 7
  s_lshl_b32 s34, s11, 7
  s_add_u32 s34, s34, s13
  s_mul_i32 s35, s11, 229376
  s_add_u32 s35, s35, s14
  s_add_u32 m0, s15, 98304
  s_add_u32 s11, s34, 0
  buffer_load_dwordx4 v1, s[52:55], s11 offen lds
  v_fma_f32 v111, v112, v99, v107
  v_cvt_pk_bf16_f32 v166, v110, v111
  v_mul_f32 v106, v111, v99
  v_mul_f32 v107, v111, v98
  v_fma_f32 v112, v110, v98, -v106
  v_fma_f32 v113, v110, v99, v107
  v_cvt_pk_bf16_f32 v167, v112, v113
  s_add_u32 m0, s15, 114688
  s_add_u32 s11, s35, 0
  buffer_load_dwordx4 v3, s[56:59], s11 offen lds
  v_mul_f32 v106, v113, v99
  v_mul_f32 v107, v113, v98
  v_fma_f32 v110, v112, v98, -v106
  v_fma_f32 v111, v112, v99, v107
  v_cvt_pk_bf16_f32 v168, v110, v111
  v_mul_f32 v106, v111, v99
  v_mul_f32 v107, v111, v98
  s_add_u32 m0, s15, 99328
  s_add_u32 s11, s34, 8192
  buffer_load_dwordx4 v2, s[52:55], s11 offen lds
  v_fma_f32 v112, v110, v98, -v106
  v_fma_f32 v113, v110, v99, v107
  v_cvt_pk_bf16_f32 v169, v112, v113
  v_mul_f32 v106, v113, v99
  v_mul_f32 v107, v113, v98
  v_fma_f32 v110, v112, v98, -v106
  v_fma_f32 v111, v112, v99, v107
  s_add_u32 m0, s15, 115712
  s_add_u32 s11, s35, 14336
  buffer_load_dwordx4 v3, s[56:59], s11 offen lds
  v_cvt_pk_bf16_f32 v170, v110, v111
  v_mul_f32 v106, v111, v99
  v_mul_f32 v107, v111, v98
  v_fma_f32 v112, v110, v98, -v106
  v_fma_f32 v113, v110, v99, v107
  v_cvt_pk_bf16_f32 v171, v112, v113
  v_mul_f32 v106, v113, v99
  s_add_u32 m0, s15, 100352
  s_add_u32 s11, s34, 16384
  buffer_load_dwordx4 v1, s[52:55], s11 offen lds
  v_mul_f32 v107, v113, v98
  v_fma_f32 v110, v112, v98, -v106
  v_fma_f32 v111, v112, v99, v107
  v_cvt_pk_bf16_f32 v172, v110, v111
  v_mul_f32 v106, v111, v99
  v_mul_f32 v107, v111, v98
  v_fma_f32 v112, v110, v98, -v106
  s_add_u32 m0, s15, 116736
  s_add_u32 s11, s35, 28672
  buffer_load_dwordx4 v3, s[56:59], s11 offen lds
  v_fma_f32 v113, v110, v99, v107
  v_cvt_pk_bf16_f32 v173, v112, v113
  v_mul_f32 v106, v113, v99
  v_mul_f32 v107, v113, v98
  v_fma_f32 v110, v112, v98, -v106
  v_fma_f32 v111, v112, v99, v107
  v_cvt_pk_bf16_f32 v174, v110, v111
  s_add_u32 m0, s15, 101376
  s_add_u32 s11, s34, 24576
  buffer_load_dwordx4 v2, s[52:55], s11 offen lds
  v_mul_f32 v106, v111, v99
  v_mul_f32 v107, v111, v98
  v_fma_f32 v112, v110, v98, -v106
  v_fma_f32 v113, v110, v99, v107
  v_cvt_pk_bf16_f32 v175, v112, v113
  v_mul_f32 v106, v113, v99
  v_mul_f32 v107, v113, v98
  s_add_u32 m0, s15, 117760
  s_add_u32 s11, s35, 43008
  buffer_load_dwordx4 v3, s[56:59], s11 offen lds
  v_fma_f32 v110, v112, v98, -v106
  v_fma_f32 v111, v112, v99, v107
  v_cvt_pk_bf16_f32 v176, v110, v111
  v_mul_f32 v106, v111, v99
  v_mul_f32 v107, v111, v98
  v_fma_f32 v112, v110, v98, -v106
  v_fma_f32 v113, v110, v99, v107
  s_mul_i32 s11, s9, 229376
  s_mul_i32 s12, s68, 28672
  s_add_u32 s11, s11, s12
  s_add_u32 s50, s11, 8388608
  s_mul_i32 s11, s8, 229376
  s_add_u32 s51, s11, s12
  s_lshr_b32 s11, s68, 1
  s_mul_i32 s11, s11, 114688
  s_sub_u32 s12, 114688, s11
  s_add_u32 s52, s50, s12
  s_add_u32 s50, s50, s11
  s_and_b32 s11, s68, 1
  s_mul_i32 s11, s11, 114688
  s_sub_u32 s12, 114688, s11
  s_add_u32 s53, s51, s12
  s_add_u32 s51, s51, s11
  s_lshl_b32 s15, s68, 11
  s_waitcnt vmcnt(9)
  s_waitcnt lgkmcnt(0)
  s_barrier
  v_cvt_pk_bf16_f32 v177, v112, v113
  s_waitcnt vmcnt(0)
  s_waitcnt lgkmcnt(0)
  s_barrier
  v_cmp_ne_u32 vcc, s10, v45
  s_nop 0
  s_cmp_lg_u64 vcc, 0
  s_cbranch_scc1 slow_30
back_31:
  v_and_b32 v18, 0xffff0000, v44
  v_lshlrev_b32 v45, 16, v44
  v_rcp_f32 v44, v18
  s_nop 0
  v_fma_f32 v19, -v18, v44, 2.0
  v_mul_f32 v44, v44, v19
  v_mul_f32 v45, v45, v44
  s_lshl_b32 s11, s68, 8
  s_add_u32 s11, s11, 161344
  v_add_u32 v16, s11, v38
  ds_write_b64 v16, v[44:45]
  s_lshl_b32 s11, s68, 7
  s_add_u32 s11, s11, 162880
  v_and_b32 v16, 15, v0
  v_lshlrev_b32 v16, 3, v16
  v_add_u32 v16, s11, v16
  v_and_b32 v43, 0xffff0000, v42
  v_lshlrev_b32 v42, 16, v42
  ds_write_b64 v16, v[42:43]
  s_waitcnt lgkmcnt(0)
  s_barrier
L_AUX2:
  s_setprio 1
  v_mov_b32 v9, v46
  s_mul_i32 s13, s69, 4608
  s_add_u32 s13, s13, 98304
  v_and_b32 v18, 15, v0
  v_lshrrev_b32 v19, 4, v0
  v_lshlrev_b32 v20, 3, v19
  v_sub_u32 v20, v20, v18
  v_add_u32 v20, 2031, v20
  v_lshrrev_b32 v20, 1, v20
  v_lshlrev_b32 v20, 2, v20
  v_and_b32 v21, 1, v18
  v_xor_b32 v21, 1, v21
  v_mul_u32_u24 v21, 4160, v21
  v_add_u32 v20, v20, v21
  s_sub_u32 s11, s95, 704
  s_lshl_b32 s92, s98, 8
  s_sub_u32 s11, s11, s92
  v_add_u32 v4, s11, v20
  v_subrev_u32 v5, 1024, v4
  v_subrev_u32 v6, 2048, v4
  v_subrev_u32 v7, 3072, v4
  v_lshlrev_b32 v20, 5, v18
  v_lshl_add_u32 v20, v19, 4, v20
  s_add_u32 s11, s13, 288
  s_sub_u32 s11, s11, s92
  v_add_u32 v8, s11, v20
  v_lshlrev_b32 v17, 3, v0
  v_add_u32 v17, s13, v17
  v_mov_b32 v18, 0
  v_mov_b32 v19, 0
  v_mov_b32 v16, 163396
  v_mov_b32 v20, 1
  v_mov_b32 v21, 2
  v_mov_b32 v22, 3
  v_mov_b32 v24, 163412
  s_lshl_b32 s11, s68, 10
  s_add_u32 s11, s11, 98816
  v_add_u32 v25, s11, v46
  s_cmp_lt_u32 s5, 28
  s_cbranch_scc1 xw_32
  s_mov_b32 s12, 262144
isp_33:
  s_sleep 1
  ds_read_b32 v23, v16
  s_sub_u32 s12, s12, 1
  s_waitcnt lgkmcnt(0)
  v_readfirstlane_b32 s11, v23
  s_nop 0
  s_cselect_b32 s61, -1, s11
  s_cmp_lt_u32 s61, 40
  s_cbranch_scc1 isp_33
xw_32:
  s_lshl_b32 s94, s9, 2
  s_add_u32 s94, s94, s68
  s_add_u32 s94, s94, 137
  s_lshl_b32 s11, s94, 6
  s_add_u32 s11, s11, 14745600
  s_load_dword s35, s[48:49], s11
  s_lshl_b32 s11, s68, 14
  s_add_u32 s11, s11, 14753792
  s_load_dword s14, s[48:49], s11
  s_mov_b32 s93, 128
  s_and_b32 s11, s99, 0x1fe
  s_lshl_b32 s11, s11, 12
  s_lshl_b32 s12, s68, 10
  s_add_u32 s11, s11, s12
  s_add_u32 s11, s11, 10485760
  v_add_u32 v219, s11, v46
  v_add_u32 v245, 0x1000, v219
  s_lshl_b32 s100, s68, 12
  s_add_u32 s100, s100, 14680064
  s_lshl_b32 s101, s68, 12
  s_add_u32 s101, s101, 49152
  v_lshlrev_b32 v218, 6, v0
  v_add_u32 v218, s101, v218
  ds_write2_b32 v118, v124, v125 offset0:0 offset1:68
  ds_write2_b32 v118, v126, v127 offset0:136 offset1:204
  ds_write2_b32 v119, v128, v129 offset0:0 offset1:68
  ds_write2_b32 v119, v130, v131 offset0:136 offset1:204
  ds_write2_b32 v120, v132, v133 offset0:0 offset1:68
  ds_write2_b32 v120, v134, v135 offset0:136 offset1:204
  ds_write2_b32 v121, v136, v137 offset0:0 offset1:68
  ds_write2_b32 v121, v138, v139 offset0:136 offset1:204
  ds_read_b128 v[48:51], v122 offset:0
  ds_read_b128 v[52:55], v122 offset:64
  ds_read_b128 v[56:59], v122 offset:128
  ds_read_b128 v[60:63], v122 offset:192
  ds_write2_b32 v118, v140, v141 offset0:0 offset1:68
  ds_write2_b32 v118, v142, v143 offset0:136 offset1:204
  ds_write2_b32 v119, v144, v144 offset0:0 offset1:68
  ds_read_b128 v[64:67], v122 offset:0
  ds_read_b128 v[68:71], v122 offset:64
  ds_read_b128 v[72:75], v122 offset:128
  ds_read_b128 v[76:79], v122 offset:192
  ds_write2_b32 v118, v146, v147 offset0:0 offset1:68
  ds_write2_b32 v118, v148, v149 offset0:136 offset1:204
  ds_write2_b32 v119, v150, v151 offset0:0 offset1:68
  ds_write2_b32 v119, v152, v153 offset0:136 offset1:204
  ds_write2_b32 v120, v154, v155 offset0:0 offset1:68
  ds_write2_b32 v120, v156, v157 offset0:136 offset1:204
  ds_write2_b32 v121, v158, v159 offset0:0 offset1:68
  ds_write2_b32 v121, v160, v161 offset0:136 offset1:204
  ds_read_b128 v[96:99], v122 offset:0
  ds_read_b128 v[100:103], v122 offset:64
  ds_read_b128 v[104:107], v122 offset:128
  ds_read_b128 v[108:111], v122 offset:192
  ds_write2_b32 v118, v162, v163 offset0:0 offset1:68
  ds_write2_b32 v118, v164, v165 offset0:136 offset1:204
  ds_write2_b32 v119, v166, v167 offset0:0 offset1:68
  ds_write2_b32 v119, v168, v169 offset0:136 offset1:204
  ds_write2_b32 v120, v170, v171 offset0:0 offset1:68
  ds_write2_b32 v120, v172, v173 offset0:136 offset1:204
  ds_write2_b32 v121, v174, v175 offset0:0 offset1:68
  ds_write2_b32 v121, v176, v177 offset0:136 offset1:204
  ds_read_b128 v[124:127], v122 offset:0
  ds_read_b128 v[128:131], v122 offset:64
  ds_read_b128 v[132:135], v122 offset:128
  ds_read_b128 v[136:139], v122 offset:192
  s_waitcnt lgkmcnt(0)
  s_add_u32 m0, s101, 0
  s_add_u32 s11, s100, 0
  buffer_load_dwordx4 v46, s[64:67], s11 offen sc1 lds
  s_add_u32 m0, s101, 1024
  s_add_u32 s11, s100, 1024
  buffer_load_dwordx4 v46, s[64:67], s11 offen sc1 lds
  s_add_u32 m0, s101, 2048
  s_add_u32 s11, s100, 2048
  buffer_load_dwordx4 v46, s[64:67], s11 offen sc1 lds
  s_add_u32 m0, s101, 3072
  s_add_u32 s11, s100, 3072
  buffer_load_dwordx4 v46, s[64:67], s11 offen sc1 lds
  s_cmp_lg_u32 s14, s10
  s_cbranch_scc1 et_34
  global_load_dwordx4 v[192:195], v219, s[48:49] sc1
  global_load_dwordx4 v[196:199], v245, s[48:49] sc1
et_34:
  s_cmp_lg_u32 s35, s10
  s_cbranch_scc1 et_35
  s_add_u32 m0, s15, 0
  s_add_u32 s62, s50, 16384
  buffer_load_dwordx4 v9, s[64:67], s62 offen sc1 lds
  s_add_u32 m0, s15, 1024
  s_add_u32 s62, s52, 16384
  buffer_load_dwordx4 v9, s[64:67], s62 offen sc1 lds
  s_add_u32 m0, s15, 8192
  s_add_u32 s62, s50, 17408
  buffer_load_dwordx4 v9, s[64:67], s62 offen sc1 lds
  s_add_u32 m0, s15, 9216
  s_add_u32 s62, s52, 17408
  buffer_load_dwordx4 v9, s[64:67], s62 offen sc1 lds
  s_add_u32 m0, s15, 16384
  s_add_u32 s62, s50, 18432
  buffer_load_dwordx4 v9, s[64:67], s62 offen sc1 lds
  s_add_u32 m0, s15, 17408
  s_add_u32 s62, s52, 18432
  buffer_load_dwordx4 v9, s[64:67], s62 offen sc1 lds
et_35:
  v_mfma_f32_16x16x32_bf16 v[80:83], v[96:99], v[48:51], 0
  v_mfma_f32_16x16x32_bf16 v[84:87], v[96:99], v[64:67], 0
  v_mfma_f32_16x16x32_bf16 v[80:83], v[100:103], v[52:55], v[80:83]
  v_mfma_f32_16x16x32_bf16 v[84:87], v[100:103], v[68:71], v[84:87]
  v_mfma_f32_16x16x32_bf16 v[80:83], v[104:107], v[56:59], v[80:83]
  v_mfma_f32_16x16x32_bf16 v[84:87], v[104:107], v[72:75], v[84:87]
  v_mfma_f32_16x16x32_bf16 v[80:83], v[108:111], v[60:63], v[80:83]
  v_mfma_f32_16x16x32_bf16 v[84:87], v[108:111], v[76:79], v[84:87]
  v_mfma_f32_16x16x32_bf16 v[88:91], v[124:127], v[48:51], 0
  v_mfma_f32_16x16x32_bf16 v[92:95], v[124:127], v[64:67], 0
  v_mfma_f32_16x16x32_bf16 v[88:91], v[128:131], v[52:55], v[88:91]
  v_mfma_f32_16x16x32_bf16 v[92:95], v[128:131], v[68:71], v[92:95]
  v_mfma_f32_16x16x32_bf16 v[88:91], v[132:135], v[56:59], v[88:91]
  v_mfma_f32_16x16x32_bf16 v[92:95], v[132:135], v[72:75], v[92:95]
  v_mfma_f32_16x16x32_bf16 v[88:91], v[136:139], v[60:63], v[88:91]
  v_mfma_f32_16x16x32_bf16 v[92:95], v[136:139], v[76:79], v[92:95]
  ds_write_b128 v123, v[80:83] offset:0
  ds_write_b128 v123, v[84:87] offset:1024
  s_nop 4
  ds_write_b128 v123, v[88:91] offset:2048
  ds_write_b128 v123, v[92:95] offset:3072
  s_lshl_b32 s11, s68, 14
  s_add_u32 s11, s11, 15212544
  s_load_dword s33, s[48:49], s11
  ds_write_b32 v188, v20
  s_mov_b32 s12, 262144
isp_36:
  s_sleep 1
  ds_read_b32 v23, v16
  s_sub_u32 s12, s12, 1
  s_waitcnt lgkmcnt(0)
  v_readfirstlane_b32 s11, v23
  s_nop 0
  s_cselect_b32 s61, -1, s11
  s_cmp_lt_u32 s61, 40
  s_cbranch_scc1 isp_36
  s_setprio 2
  ds_write_b64 v17, v[18:19]
  s_cmp_eq_u32 s14, s10
  s_cselect_b32 s33, 0, s33
  s_cmp_lg_u32 s33, s10
  s_cbranch_scc1 mt_37
  global_load_dwordx4 v[192:195], v219, s[48:49] sc1
  global_load_dwordx4 v[196:199], v245, s[48:49] sc1
  s_mov_b32 s14, s10
mt_37:
  s_mov_b32 s12, 262144
isp_38:
  ds_read_b32 v16, v189
  s_sub_u32 s12, s12, 1
  s_waitcnt lgkmcnt(0)
  v_readfirstlane_b32 s11, v16
  s_nop 0
  s_cselect_b32 s61, -1, s11
  s_cmp_lt_u32 s61, 1
  s_cbranch_scc1 isp_38
  ds_read_b128 v[48:51], v246 offset:0
  ds_read_b128 v[56:59], v247 offset:0
  ds_read_b128 v[52:55], v246 offset:1024
  ds_read_b128 v[60:63], v247 offset:1024
  s_waitcnt lgkmcnt(0)
  v_add_f32 v48, v48, v56
  v_add_f32 v49, v49, v57
  v_add_f32 v50, v50, v58
  v_add_f32 v51, v51, v59
  v_add_f32 v52, v52, v60
  v_add_f32 v53, v53, v61
  v_add_f32 v54, v54, v62
  v_add_f32 v55, v55, v63
  v_cvt_pk_bf16_f32 v56, v48, v49
  v_cvt_pk_bf16_f32 v57, v50, v51
  v_cvt_pk_bf16_f32 v58, v52, v53
  v_cvt_pk_bf16_f32 v59, v54, v55
  ds_write_b16 v220, v56
  ds_write_b16_d16_hi v221, v56
  ds_write_b16 v222, v57
  ds_write_b16_d16_hi v223, v57
  ds_write_b16 v224, v58
  ds_write_b16_d16_hi v225, v58
  ds_write_b16 v226, v59
  ds_write_b16_d16_hi v227, v59
  ds_write_b32 v188, v21
  s_mov_b32 s12, 262144
isp_39:
  ds_read_b32 v16, v189
  s_sub_u32 s12, s12, 1
  s_waitcnt lgkmcnt(0)
  v_readfirstlane_b32 s11, v16
  s_nop 0
  s_cselect_b32 s61, -1, s11
  s_cmp_lt_u32 s61, 2
  s_cbranch_scc1 isp_39
  s_cmp_lg_u32 s14, s10
  s_cbranch_scc1 slow_40
back_41:
  ds_read_u16 v80, v228
  ds_read_u16 v81, v229
  ds_read_u16 v82, v230
  ds_read_u16 v83, v231
  ds_read_u16 v84, v232
  ds_read_u16 v85, v233
  ds_read_u16 v86, v234
  ds_read_u16 v87, v235
  ds_read_u16 v88, v236
  ds_read_u16 v89, v237
  ds_read_u16 v90, v238
  ds_read_u16 v91, v239
  ds_read_u16 v92, v240
  ds_read_u16 v93, v241
  ds_read_u16 v94, v242
  ds_read_u16 v95, v243
  ds_read_u16 v96, v244
  s_waitcnt lgkmcnt(0)
  v_lshl_or_b32 v48, v81, 16, v80
  v_lshl_or_b32 v60, v82, 16, v81
  v_lshl_or_b32 v49, v83, 16, v82
  v_lshl_or_b32 v61, v84, 16, v83
  v_lshl_or_b32 v50, v85, 16, v84
  v_lshl_or_b32 v62, v86, 16, v85
  v_lshl_or_b32 v51, v87, 16, v86
  v_lshl_or_b32 v63, v88, 16, v87
  v_lshl_or_b32 v52, v89, 16, v88
  v_lshl_or_b32 v64, v90, 16, v89
  v_lshl_or_b32 v53, v91, 16, v90
  v_lshl_or_b32 v65, v92, 16, v91
  v_lshl_or_b32 v54, v93, 16, v92
  v_lshl_or_b32 v66, v94, 16, v93
  v_lshl_or_b32 v55, v95, 16, v94
  v_lshl_or_b32 v67, v96, 16, v95
  ds_write_b128 v248, v[48:51]
  ds_write_b128 v248, v[52:55] offset:16
  ds_write_b128 v248, v[60:63] offset:4160
  ds_write_b128 v248, v[64:67] offset:4176
  ds_write_b32 v249, v47 offset:4096
  ds_write_b32 v249, v47 offset:8256
  ds_write_b32 v188, v22
  s_cmp_eq_u32 s35, s10
  s_cselect_b32 s12, 1, 2
  s_lshl_b32 s11, s68, 2
  s_add_u32 s11, s11, 163440
  v_mov_b32 v26, s11
  v_mov_b32 v27, s12
  s_waitcnt vmcnt(0)
  ds_write_b32 v26, v27
  ds_read_b128 v[200:203], v218 offset:0
  ds_read_b128 v[204:207], v218 offset:16
  ds_read_b128 v[208:211], v218 offset:32
  ds_read_b128 v[212:215], v218 offset:48
  s_waitcnt lgkmcnt(0)
  v_xor_b32 v26, s10, v201
  v_xor_b32 v27, s10, v203
  v_or_b32 v26, v26, v27
  v_xor_b32 v27, s10, v205
  v_or_b32 v26, v26, v27
  v_xor_b32 v27, s10, v207
  v_or_b32 v26, v26, v27
  v_xor_b32 v27, s10, v209
  v_or_b32 v26, v26, v27
  v_xor_b32 v27, s10, v211
  v_or_b32 v26, v26, v27
  v_xor_b32 v27, s10, v213
  v_or_b32 v26, v26, v27
  v_xor_b32 v27, s10, v215
  v_or_b32 v26, v26, v27
  v_cmp_ne_u32 vcc, 0, v26
  s_nop 0
  s_cmp_lg_u64 vcc, 0
  s_cbranch_scc1 slow_42
back_43:
  v_and_b32 v201, 0xffff0000, v200
  v_and_b32 v203, 0xffff0000, v202
  v_and_b32 v205, 0xffff0000, v204
  v_and_b32 v207, 0xffff0000, v206
  v_and_b32 v209, 0xffff0000, v208
  v_and_b32 v211, 0xffff0000, v210
  v_and_b32 v213, 0xffff0000, v212
  v_and_b32 v215, 0xffff0000, v214
  v_rcp_f32 v201, v201
  v_lshlrev_b32 v200, 16, v200
  v_rcp_f32 v203, v203
  v_lshlrev_b32 v202, 16, v202
  v_rcp_f32 v205, v205
  v_lshlrev_b32 v204, 16, v204
  v_rcp_f32 v207, v207
  v_lshlrev_b32 v206, 16, v206
  v_rcp_f32 v209, v209
  v_lshlrev_b32 v208, 16, v208
  v_rcp_f32 v211, v211
  v_lshlrev_b32 v210, 16, v210
  v_rcp_f32 v213, v213
  v_lshlrev_b32 v212, 16, v212
  v_rcp_f32 v215, v215
  v_lshlrev_b32 v214, 16, v214
  v_mul_f32 v200, v200, v201
  v_mul_f32 v202, v202, v203
  v_mul_f32 v204, v204, v205
  v_mul_f32 v206, v206, v207
  v_mul_f32 v208, v208, v209
  v_mul_f32 v210, v210, v211
  v_mul_f32 v212, v212, v213
  v_mul_f32 v214, v214, v215
  v_lshlrev_b32 v26, 16, v192
  v_and_b32 v27, 0xffff0000, v192
  v_fma_f32 v26, v26, v201, -v200
  v_fma_f32 v27, v27, v203, -v202
  v_cvt_pk_bf16_f32 v192, v26, v27
  v_lshlrev_b32 v26, 16, v193
  v_and_b32 v27, 0xffff0000, v193
  v_fma_f32 v26, v26, v205, -v204
  v_fma_f32 v27, v27, v207, -v206
  v_cvt_pk_bf16_f32 v193, v26, v27
  v_lshlrev_b32 v26, 16, v194
  v_and_b32 v27, 0xffff0000, v194
  v_fma_f32 v26, v26, v209, -v208
  v_fma_f32 v27, v27, v211, -v210
  v_cvt_pk_bf16_f32 v194, v26, v27
  v_lshlrev_b32 v26, 16, v195
  v_and_b32 v27, 0xffff0000, v195
  v_fma_f32 v26, v26, v213, -v212
  v_fma_f32 v27, v27, v215, -v214
  v_cvt_pk_bf16_f32 v195, v26, v27
  v_lshlrev_b32 v26, 16, v196
  v_and_b32 v27, 0xffff0000, v196
  v_fma_f32 v26, v26, v201, -v200
  v_fma_f32 v27, v27, v203, -v202
  v_cvt_pk_bf16_f32 v196, v26, v27
  v_lshlrev_b32 v26, 16, v197
  v_and_b32 v27, 0xffff0000, v197
  v_fma_f32 v26, v26, v205, -v204
  v_fma_f32 v27, v27, v207, -v206
  v_cvt_pk_bf16_f32 v197, v26, v27
  v_lshlrev_b32 v26, 16, v198
  v_and_b32 v27, 0xffff0000, v198
  v_fma_f32 v26, v26, v209, -v208
  v_fma_f32 v27, v27, v211, -v210
  v_cvt_pk_bf16_f32 v198, v26, v27
  v_lshlrev_b32 v26, 16, v199
  v_and_b32 v27, 0xffff0000, v199
  v_fma_f32 v26, v26, v213, -v212
  v_fma_f32 v27, v27, v215, -v214
  v_cvt_pk_bf16_f32 v199, v26, v27
  ds_write_b128 v25, v[192:195] offset:0
  ds_write_b128 v25, v[196:199] offset:4608
  s_mov_b64 exec, 1
  ds_add_u32 v24, v20
  s_mov_b64 exec, -1
  s_mov_b32 s12, 262144
isp_44:
  ds_read_b32 v16, v189
  s_sub_u32 s12, s12, 1
  s_waitcnt lgkmcnt(0)
  v_readfirstlane_b32 s11, v16
  s_nop 0
  s_cselect_b32 s61, -1, s11
  s_cmp_lt_u32 s61, 3
  s_cbranch_scc1 isp_44
  s_setprio 1
  s_mov_b32 s12, 262144
isp_45:
  ds_read_b32 v17, v24
  s_sub_u32 s12, s12, 1
  s_waitcnt lgkmcnt(0)
  v_readfirstlane_b32 s11, v17
  s_nop 0
  s_cselect_b32 s61, -1, s11
  s_cmp_lt_u32 s61, 4
  s_cbranch_scc1 isp_45
  s_lshl_b32 s11, s68, 2
  s_add_u32 s11, s11, 163472
  v_mov_b32 v16, s11
  s_mov_b32 s12, 262144
isp_46:
  s_sleep 1
  ds_read_b32 v17, v16
  s_sub_u32 s12, s12, 1
  s_waitcnt lgkmcnt(0)
  v_readfirstlane_b32 s11, v17
  s_nop 0
  s_cselect_b32 s61, -1, s11
  s_cmp_lt_u32 s61, 1
  s_cbranch_scc1 isp_46
  s_setprio 3
  s_waitcnt lgkmcnt(0)
  ds_read2_b32 v[48:49], v4 offset0:176 offset1:177
  ds_read2_b32 v[50:51], v4 offset0:178 offset1:179
  ds_read_b128 v[80:83], v8 offset:192
  ds_read2_b32 v[52:53], v4 offset0:48 offset1:49
  ds_read2_b32 v[54:55], v4 offset0:50 offset1:51
  ds_read_b128 v[84:87], v8 offset:704
  ds_read2_b32 v[56:57], v5 offset0:176 offset1:177
  ds_read2_b32 v[58:59], v5 offset0:178 offset1:179
  ds_read_b128 v[88:91], v8 offset:1216
  ds_read2_b32 v[60:61], v5 offset0:48 offset1:49
  ds_read2_b32 v[62:63], v5 offset0:50 offset1:51
  ds_read_b128 v[92:95], v8 offset:1728
  ds_read2_b32 v[64:65], v6 offset0:176 offset1:177
  ds_read2_b32 v[66:67], v6 offset0:178 offset1:179
  ds_read_b128 v[96:99], v8 offset:2240
  ds_read2_b32 v[68:69], v6 offset0:48 offset1:49
  ds_read2_b32 v[70:71], v6 offset0:50 offset1:51
  ds_read_b128 v[100:103], v8 offset:2752
  ds_read2_b32 v[72:73], v7 offset0:176 offset1:177
  ds_read2_b32 v[74:75], v7 offset0:178 offset1:179
  ds_read_b128 v[104:107], v8 offset:3264
  ds_read2_b32 v[76:77], v7 offset0:48 offset1:49
  ds_read2_b32 v[78:79], v7 offset0:50 offset1:51
  ds_read_b128 v[108:111], v8 offset:3776
  s_waitcnt lgkmcnt(15)
  v_mfma_f32_16x16x32_bf16 v[16:19], v[48:51], v[80:83], 0
  v_mfma_f32_16x16x32_bf16 v[20:23], v[48:51], v[84:87], 0
  v_mfma_f32_16x16x32_bf16 v[20:23], v[52:55], v[80:83], v[20:23]
  v_mfma_f32_16x16x32_bf16 v[24:27], v[52:55], v[84:87], 0
  v_mfma_f32_16x16x32_bf16 v[24:27], v[48:51], v[88:91], v[24:27]
  v_mfma_f32_16x16x32_bf16 v[28:31], v[52:55], v[88:91], 0
  v_mfma_f32_16x16x32_bf16 v[24:27], v[56:59], v[80:83], v[24:27]
  v_mfma_f32_16x16x32_bf16 v[28:31], v[56:59], v[84:87], v[28:31]
  v_mfma_f32_16x16x32_bf16 v[32:35], v[56:59], v[88:91], 0
  ds_read2_b32 v[112:113], v4 offset0:160 offset1:161
  s_waitcnt lgkmcnt(13)
  v_mfma_f32_16x16x32_bf16 v[28:31], v[48:51], v[92:95], v[28:31]
  ds_read2_b32 v[114:115], v4 offset0:162 offset1:163
  v_mfma_f32_16x16x32_bf16 v[32:35], v[52:55], v[92:95], v[32:35]
  ds_read_b128 v[144:147], v8 offset:128
  v_mfma_f32_16x16x32_bf16 v[36:39], v[56:59], v[92:95], 0
  ds_read2_b32 v[116:117], v4 offset0:32 offset1:33
  v_mfma_f32_16x16x32_bf16 v[28:31], v[60:63], v[80:83], v[28:31]
  ds_read2_b32 v[118:119], v4 offset0:34 offset1:35
  v_mfma_f32_16x16x32_bf16 v[32:35], v[60:63], v[84:87], v[32:35]
  ds_read_b128 v[148:151], v8 offset:640
  v_mfma_f32_16x16x32_bf16 v[36:39], v[60:63], v[88:91], v[36:39]
  ds_read2_b32 v[120:121], v5 offset0:160 offset1:161
  v_mfma_f32_16x16x32_bf16 v[40:43], v[60:63], v[92:95], 0
  ds_read2_b32 v[122:123], v5 offset0:162 offset1:163
  s_waitcnt lgkmcnt(15)
  v_mfma_f32_16x16x32_bf16 v[32:35], v[48:51], v[96:99], v[32:35]
  ds_read_b128 v[152:155], v8 offset:1152
  v_mfma_f32_16x16x32_bf16 v[36:39], v[52:55], v[96:99], v[36:39]
  ds_read2_b32 v[124:125], v5 offset0:32 offset1:33
  v_mfma_f32_16x16x32_bf16 v[40:43], v[56:59], v[96:99], v[40:43]
  ds_read2_b32 v[126:127], v5 offset0:34 offset1:35
  v_mfma_f32_16x16x32_bf16 v[44:47], v[60:63], v[96:99], 0
  ds_read_b128 v[156:159], v8 offset:1664
  v_mfma_f32_16x16x32_bf16 v[32:35], v[64:67], v[80:83], v[32:35]
  ds_read2_b32 v[128:129], v6 offset0:160 offset1:161
  v_mfma_f32_16x16x32_bf16 v[36:39], v[64:67], v[84:87], v[36:39]
  ds_read2_b32 v[130:131], v6 offset0:162 offset1:163
  v_mfma_f32_16x16x32_bf16 v[40:43], v[64:67], v[88:91], v[40:43]
  ds_read_b128 v[160:163], v8 offset:2176
  v_mfma_f32_16x16x32_bf16 v[44:47], v[64:67], v[92:95], v[44:47]
  ds_read2_b32 v[132:133], v6 offset0:32 offset1:33
  s_waitcnt lgkmcnt(15)
  v_mfma_f32_16x16x32_bf16 v[36:39], v[48:51], v[100:103], v[36:39]
  ds_read2_b32 v[134:135], v6 offset0:34 offset1:35
  v_mfma_f32_16x16x32_bf16 v[40:43], v[52:55], v[100:103], v[40:43]
  ds_read_b128 v[164:167], v8 offset:2688
  v_mfma_f32_16x16x32_bf16 v[44:47], v[56:59], v[100:103], v[44:47]
  ds_read2_b32 v[136:137], v7 offset0:160 offset1:161
  v_mfma_f32_16x16x32_bf16 v[36:39], v[68:71], v[80:83], v[36:39]
  ds_read2_b32 v[138:139], v7 offset0:162 offset1:163
  v_mfma_f32_16x16x32_bf16 v[40:43], v[68:71], v[84:87], v[40:43]
  ds_read_b128 v[168:171], v8 offset:3200
  v_mfma_f32_16x16x32_bf16 v[44:47], v[68:71], v[88:91], v[44:47]
  ds_read2_b32 v[140:141], v7 offset0:32 offset1:33
  v_mfma_f32_16x16x32_bf16 v[40:43], v[48:51], v[104:107], v[40:43]
  ds_read2_b32 v[142:143], v7 offset0:34 offset1:35
  v_mfma_f32_16x16x32_bf16 v[44:47], v[52:55], v[104:107], v[44:47]
  ds_read_b128 v[172:175], v8 offset:3712
  v_mfma_f32_16x16x32_bf16 v[40:43], v[72:75], v[80:83], v[40:43]
  v_mfma_f32_16x16x32_bf16 v[44:47], v[72:75], v[84:87], v[44:47]
  v_mfma_f32_16x16x32_bf16 v[44:47], v[48:51], v[108:111], v[44:47]
  v_mfma_f32_16x16x32_bf16 v[44:47], v[76:79], v[80:83], v[44:47]
  s_waitcnt lgkmcnt(15)
  v_mfma_f32_16x16x32_bf16 v[16:19], v[112:115], v[144:147], v[16:19]
  v_mfma_f32_16x16x32_bf16 v[20:23], v[112:115], v[148:151], v[20:23]
  v_mfma_f32_16x16x32_bf16 v[20:23], v[116:119], v[144:147], v[20:23]
  v_mfma_f32_16x16x32_bf16 v[24:27], v[116:119], v[148:151], v[24:27]
  v_mfma_f32_16x16x32_bf16 v[24:27], v[112:115], v[152:155], v[24:27]
  v_mfma_f32_16x16x32_bf16 v[28:31], v[116:119], v[152:155], v[28:31]
  v_mfma_f32_16x16x32_bf16 v[24:27], v[120:123], v[144:147], v[24:27]
  v_mfma_f32_16x16x32_bf16 v[28:31], v[120:123], v[148:151], v[28:31]
  v_mfma_f32_16x16x32_bf16 v[32:35], v[120:123], v[152:155], v[32:35]
  ds_read2_b32 v[48:49], v4 offset0:144 offset1:145
  s_waitcnt lgkmcnt(13)
  v_mfma_f32_16x16x32_bf16 v[28:31], v[112:115], v[156:159], v[28:31]
  ds_read2_b32 v[50:51], v4 offset0:146 offset1:147
  v_mfma_f32_16x16x32_bf16 v[32:35], v[116:119], v[156:159], v[32:35]
  ds_read_b128 v[80:83], v8 offset:64
  v_mfma_f32_16x16x32_bf16 v[36:39], v[120:123], v[156:159], v[36:39]
  ds_read2_b32 v[52:53], v4 offset0:16 offset1:17
  v_mfma_f32_16x16x32_bf16 v[28:31], v[124:127], v[144:147], v[28:31]
  ds_read2_b32 v[54:55], v4 offset0:18 offset1:19
  v_mfma_f32_16x16x32_bf16 v[32:35], v[124:127], v[148:151], v[32:35]
  ds_read_b128 v[84:87], v8 offset:576
  v_mfma_f32_16x16x32_bf16 v[36:39], v[124:127], v[152:155], v[36:39]
  ds_read2_b32 v[56:57], v5 offset0:144 offset1:145
  v_mfma_f32_16x16x32_bf16 v[40:43], v[124:127], v[156:159], v[40:43]
  ds_read2_b32 v[58:59], v5 offset0:146 offset1:147
  s_waitcnt lgkmcnt(15)
  v_mfma_f32_16x16x32_bf16 v[32:35], v[112:115], v[160:163], v[32:35]
  ds_read_b128 v[88:91], v8 offset:1088
  v_mfma_f32_16x16x32_bf16 v[36:39], v[116:119], v[160:163], v[36:39]
  ds_read2_b32 v[60:61], v5 offset0:16 offset1:17
  v_mfma_f32_16x16x32_bf16 v[40:43], v[120:123], v[160:163], v[40:43]
  ds_read2_b32 v[62:63], v5 offset0:18 offset1:19
  v_mfma_f32_16x16x32_bf16 v[44:47], v[124:127], v[160:163], v[44:47]
  ds_read_b128 v[92:95], v8 offset:1600
  v_mfma_f32_16x16x32_bf16 v[32:35], v[128:131], v[144:147], v[32:35]
  ds_read2_b32 v[64:65], v6 offset0:144 offset1:145
  v_mfma_f32_16x16x32_bf16 v[36:39], v[128:131], v[148:151], v[36:39]
  ds_read2_b32 v[66:67], v6 offset0:146 offset1:147
  v_mfma_f32_16x16x32_bf16 v[40:43], v[128:131], v[152:155], v[40:43]
  ds_read_b128 v[96:99], v8 offset:2112
  v_mfma_f32_16x16x32_bf16 v[44:47], v[128:131], v[156:159], v[44:47]
  ds_read2_b32 v[68:69], v6 offset0:16 offset1:17
  s_waitcnt lgkmcnt(15)
  v_mfma_f32_16x16x32_bf16 v[36:39], v[112:115], v[164:167], v[36:39]
  ds_read2_b32 v[70:71], v6 offset0:18 offset1:19
  v_mfma_f32_16x16x32_bf16 v[40:43], v[116:119], v[164:167], v[40:43]
  ds_read_b128 v[100:103], v8 offset:2624
  v_mfma_f32_16x16x32_bf16 v[44:47], v[120:123], v[164:167], v[44:47]
  ds_read2_b32 v[72:73], v7 offset0:144 offset1:145
  v_mfma_f32_16x16x32_bf16 v[36:39], v[132:135], v[144:147], v[36:39]
  ds_read2_b32 v[74:75], v7 offset0:146 offset1:147
  v_mfma_f32_16x16x32_bf16 v[40:43], v[132:135], v[148:151], v[40:43]
  ds_read_b128 v[104:107], v8 offset:3136
  v_mfma_f32_16x16x32_bf16 v[44:47], v[132:135], v[152:155], v[44:47]
  ds_read2_b32 v[76:77], v7 offset0:16 offset1:17
  v_mfma_f32_16x16x32_bf16 v[40:43], v[112:115], v[168:171], v[40:43]
  ds_read2_b32 v[78:79], v7 offset0:18 offset1:19
  v_mfma_f32_16x16x32_bf16 v[44:47], v[116:119], v[168:171], v[44:47]
  ds_read_b128 v[108:111], v8 offset:3648
  v_mfma_f32_16x16x32_bf16 v[40:43], v[136:139], v[144:147], v[40:43]
  v_mfma_f32_16x16x32_bf16 v[44:47], v[136:139], v[148:151], v[44:47]
  v_mfma_f32_16x16x32_bf16 v[44:47], v[112:115], v[172:175], v[44:47]
  v_mfma_f32_16x16x32_bf16 v[44:47], v[140:143], v[144:147], v[44:47]
  s_waitcnt lgkmcnt(15)
  v_mfma_f32_16x16x32_bf16 v[16:19], v[48:51], v[80:83], v[16:19]
  v_mfma_f32_16x16x32_bf16 v[20:23], v[48:51], v[84:87], v[20:23]
  v_mfma_f32_16x16x32_bf16 v[20:23], v[52:55], v[80:83], v[20:23]
  v_mfma_f32_16x16x32_bf16 v[24:27], v[52:55], v[84:87], v[24:27]
  v_mfma_f32_16x16x32_bf16 v[24:27], v[48:51], v[88:91], v[24:27]
  v_mfma_f32_16x16x32_bf16 v[28:31], v[52:55], v[88:91], v[28:31]
  v_mfma_f32_16x16x32_bf16 v[24:27], v[56:59], v[80:83], v[24:27]
  v_mfma_f32_16x16x32_bf16 v[28:31], v[56:59], v[84:87], v[28:31]
  v_mfma_f32_16x16x32_bf16 v[32:35], v[56:59], v[88:91], v[32:35]
  ds_read2_b32 v[112:113], v4 offset0:128 offset1:129
  s_waitcnt lgkmcnt(13)
  v_mfma_f32_16x16x32_bf16 v[28:31], v[48:51], v[92:95], v[28:31]
  ds_read2_b32 v[114:115], v4 offset0:130 offset1:131
  v_mfma_f32_16x16x32_bf16 v[32:35], v[52:55], v[92:95], v[32:35]
  ds_read_b128 v[144:147], v8 offset:0
  v_mfma_f32_16x16x32_bf16 v[36:39], v[56:59], v[92:95], v[36:39]
  ds_read2_b32 v[116:117], v4 offset0:0 offset1:1
  v_mfma_f32_16x16x32_bf16 v[28:31], v[60:63], v[80:83], v[28:31]
  ds_read2_b32 v[118:119], v4 offset0:2 offset1:3
  v_mfma_f32_16x16x32_bf16 v[32:35], v[60:63], v[84:87], v[32:35]
  ds_read_b128 v[148:151], v8 offset:512
  v_mfma_f32_16x16x32_bf16 v[36:39], v[60:63], v[88:91], v[36:39]
  ds_read2_b32 v[120:121], v5 offset0:128 offset1:129
  v_mfma_f32_16x16x32_bf16 v[40:43], v[60:63], v[92:95], v[40:43]
  ds_read2_b32 v[122:123], v5 offset0:130 offset1:131
  s_waitcnt lgkmcnt(15)
  v_mfma_f32_16x16x32_bf16 v[32:35], v[48:51], v[96:99], v[32:35]
  ds_read_b128 v[152:155], v8 offset:1024
  v_mfma_f32_16x16x32_bf16 v[36:39], v[52:55], v[96:99], v[36:39]
  ds_read2_b32 v[124:125], v5 offset0:0 offset1:1
  v_mfma_f32_16x16x32_bf16 v[40:43], v[56:59], v[96:99], v[40:43]
  ds_read2_b32 v[126:127], v5 offset0:2 offset1:3
  v_mfma_f32_16x16x32_bf16 v[44:47], v[60:63], v[96:99], v[44:47]
  ds_read_b128 v[156:159], v8 offset:1536
  v_mfma_f32_16x16x32_bf16 v[32:35], v[64:67], v[80:83], v[32:35]
  ds_read2_b32 v[128:129], v6 offset0:128 offset1:129
  v_mfma_f32_16x16x32_bf16 v[36:39], v[64:67], v[84:87], v[36:39]
  ds_read2_b32 v[130:131], v6 offset0:130 offset1:131
  v_mfma_f32_16x16x32_bf16 v[40:43], v[64:67], v[88:91], v[40:43]
  ds_read_b128 v[160:163], v8 offset:2048
  v_mfma_f32_16x16x32_bf16 v[44:47], v[64:67], v[92:95], v[44:47]
  ds_read2_b32 v[132:133], v6 offset0:0 offset1:1
  s_waitcnt lgkmcnt(15)
  v_mfma_f32_16x16x32_bf16 v[36:39], v[48:51], v[100:103], v[36:39]
  ds_read2_b32 v[134:135], v6 offset0:2 offset1:3
  v_mfma_f32_16x16x32_bf16 v[40:43], v[52:55], v[100:103], v[40:43]
  ds_read_b128 v[164:167], v8 offset:2560
  v_mfma_f32_16x16x32_bf16 v[44:47], v[56:59], v[100:103], v[44:47]
  ds_read2_b32 v[136:137], v7 offset0:128 offset1:129
  v_mfma_f32_16x16x32_bf16 v[36:39], v[68:71], v[80:83], v[36:39]
  ds_read2_b32 v[138:139], v7 offset0:130 offset1:131
  v_mfma_f32_16x16x32_bf16 v[40:43], v[68:71], v[84:87], v[40:43]
  ds_read_b128 v[168:171], v8 offset:3072
  v_mfma_f32_16x16x32_bf16 v[44:47], v[68:71], v[88:91], v[44:47]
  ds_read2_b32 v[140:141], v7 offset0:0 offset1:1
  v_mfma_f32_16x16x32_bf16 v[40:43], v[48:51], v[104:107], v[40:43]
  ds_read2_b32 v[142:143], v7 offset0:2 offset1:3
  v_mfma_f32_16x16x32_bf16 v[44:47], v[52:55], v[104:107], v[44:47]
  ds_read_b128 v[172:175], v8 offset:3584
  v_mfma_f32_16x16x32_bf16 v[40:43], v[72:75], v[80:83], v[40:43]
  v_mfma_f32_16x16x32_bf16 v[44:47], v[72:75], v[84:87], v[44:47]
  v_mfma_f32_16x16x32_bf16 v[44:47], v[48:51], v[108:111], v[44:47]
  v_mfma_f32_16x16x32_bf16 v[44:47], v[76:79], v[80:83], v[44:47]
  s_waitcnt lgkmcnt(15)
  v_mfma_f32_16x16x32_bf16 v[16:19], v[112:115], v[144:147], v[16:19]
  v_mfma_f32_16x16x32_bf16 v[20:23], v[112:115], v[148:151], v[20:23]
  v_mfma_f32_16x16x32_bf16 v[20:23], v[116:119], v[144:147], v[20:23]
  v_mfma_f32_16x16x32_bf16 v[24:27], v[116:119], v[148:151], v[24:27]
  v_mfma_f32_16x16x32_bf16 v[24:27], v[112:115], v[152:155], v[24:27]
  v_mfma_f32_16x16x32_bf16 v[28:31], v[116:119], v[152:155], v[28:31]
  v_mfma_f32_16x16x32_bf16 v[24:27], v[120:123], v[144:147], v[24:27]
  v_mfma_f32_16x16x32_bf16 v[28:31], v[120:123], v[148:151], v[28:31]
  v_mfma_f32_16x16x32_bf16 v[32:35], v[120:123], v[152:155], v[32:35]
  s_waitcnt lgkmcnt(12)
  v_mfma_f32_16x16x32_bf16 v[28:31], v[112:115], v[156:159], v[28:31]
  v_mfma_f32_16x16x32_bf16 v[32:35], v[116:119], v[156:159], v[32:35]
  v_mfma_f32_16x16x32_bf16 v[36:39], v[120:123], v[156:159], v[36:39]
  v_mfma_f32_16x16x32_bf16 v[28:31], v[124:127], v[144:147], v[28:31]
  v_mfma_f32_16x16x32_bf16 v[32:35], v[124:127], v[148:151], v[32:35]
  v_mfma_f32_16x16x32_bf16 v[36:39], v[124:127], v[152:155], v[36:39]
  v_mfma_f32_16x16x32_bf16 v[40:43], v[124:127], v[156:159], v[40:43]
  s_waitcnt lgkmcnt(9)
  v_mfma_f32_16x16x32_bf16 v[32:35], v[112:115], v[160:163], v[32:35]
  v_mfma_f32_16x16x32_bf16 v[36:39], v[116:119], v[160:163], v[36:39]
  v_mfma_f32_16x16x32_bf16 v[40:43], v[120:123], v[160:163], v[40:43]
  v_mfma_f32_16x16x32_bf16 v[44:47], v[124:127], v[160:163], v[44:47]
  v_mfma_f32_16x16x32_bf16 v[32:35], v[128:131], v[144:147], v[32:35]
  v_mfma_f32_16x16x32_bf16 v[36:39], v[128:131], v[148:151], v[36:39]
  v_mfma_f32_16x16x32_bf16 v[40:43], v[128:131], v[152:155], v[40:43]
  v_mfma_f32_16x16x32_bf16 v[44:47], v[128:131], v[156:159], v[44:47]
  s_waitcnt lgkmcnt(6)
  v_mfma_f32_16x16x32_bf16 v[36:39], v[112:115], v[164:167], v[36:39]
  v_mfma_f32_16x16x32_bf16 v[40:43], v[116:119], v[164:167], v[40:43]
  v_mfma_f32_16x16x32_bf16 v[44:47], v[120:123], v[164:167], v[44:47]
  v_mfma_f32_16x16x32_bf16 v[36:39], v[132:135], v[144:147], v[36:39]
  v_mfma_f32_16x16x32_bf16 v[40:43], v[132:135], v[148:151], v[40:43]
  v_mfma_f32_16x16x32_bf16 v[44:47], v[132:135], v[152:155], v[44:47]
  s_waitcnt lgkmcnt(3)
  v_mfma_f32_16x16x32_bf16 v[40:43], v[112:115], v[168:171], v[40:43]
  v_mfma_f32_16x16x32_bf16 v[44:47], v[116:119], v[168:171], v[44:47]
  v_mfma_f32_16x16x32_bf16 v[40:43], v[136:139], v[144:147], v[40:43]
  v_mfma_f32_16x16x32_bf16 v[44:47], v[136:139], v[148:151], v[44:47]
  s_waitcnt lgkmcnt(0)
  v_mfma_f32_16x16x32_bf16 v[44:47], v[112:115], v[172:175], v[44:47]
  v_mfma_f32_16x16x32_bf16 v[44:47], v[140:143], v[144:147], v[44:47]
  v_and_b32 v12, 15, v0
  v_lshrrev_b32 v13, 4, v0
  v_lshl_add_u32 v12, v12, 2, v13
  v_bfe_u32 v13, v12, 3, 3
  v_xor_b32 v12, v12, v13
  v_lshlrev_b32 v12, 4, v12
  v_bfe_u32 v13, v0, 3, 3
  v_xor_b32 v13, v13, v0
  v_lshlrev_b32 v13, 4, v13
  s_xor_b32 s11, s68, 1
  s_lshl_b32 s11, s11, 12
  s_add_u32 s11, s11, 116736
  v_add_u32 v10, s11, v12
  s_lshl_b32 s11, s68, 12
  s_add_u32 s11, s11, 116736
  v_add_u32 v11, s11, v9
  v_add_u32 v12, s11, v12
  v_add_u32 v13, s11, v13
  s_cmp_eq_u32 s98, 0
  s_cbranch_scc1 cx_47
  ds_write_b128 v10, v[16:19] offset:0
  ds_write_b128 v10, v[20:23] offset:1024
  ds_write_b128 v10, v[24:27] offset:2048
  ds_write_b128 v10, v[28:31] offset:3072
  s_waitcnt lgkmcnt(0)
  v_mov_b32 v16, v32
  v_mov_b32 v17, v33
  v_mov_b32 v18, v34
  v_mov_b32 v19, v35
  v_mov_b32 v20, v36
  v_mov_b32 v21, v37
  v_mov_b32 v22, v38
  v_mov_b32 v23, v39
  v_mov_b32 v24, v40
  v_mov_b32 v25, v41
  v_mov_b32 v26, v42
  v_mov_b32 v27, v43
  v_mov_b32 v28, v44
  v_mov_b32 v29, v45
  v_mov_b32 v30, v46
  v_mov_b32 v31, v47
  s_branch cx_48
cx_47:
  s_nop 7
  ds_write_b128 v10, v[32:35] offset:0
  ds_write_b128 v10, v[36:39] offset:1024
  ds_write_b128 v10, v[40:43] offset:2048
  ds_write_b128 v10, v[44:47] offset:3072
cx_48:
  v_mov_b32 v14, 4
  ds_write_b32 v188, v14
  s_lshl_b32 s92, s98, 11
  s_add_u32 s11, s13, s92
  v_lshlrev_b32 v15, 3, v0
  v_add_u32 v15, s11, v15
  ds_read_b64 v[80:81], v15 offset:512
  ds_read_b64 v[82:83], v15 offset:1024
  ds_read_b64 v[84:85], v15 offset:1536
  ds_read_b64 v[86:87], v15 offset:2048
  s_lshl_b32 s11, s99, 12
  s_add_u32 s11, s11, s92
  s_add_u32 s11, s11, 12582912
  v_lshlrev_b32 v15, 3, v0
  v_add_u32 v15, s11, v15
  v_lshlrev_b32 v217, 16, v217
  s_mov_b32 s12, 262144
isp_49:
  ds_read_b32 v14, v189
  s_sub_u32 s12, s12, 1
  s_waitcnt lgkmcnt(0)
  v_readfirstlane_b32 s11, v14
  s_nop 0
  s_cselect_b32 s61, -1, s11
  s_cmp_lt_u32 s61, 4
  s_cbranch_scc1 isp_49
  ds_read_b128 v[48:51], v13 offset:0
  ds_read_b128 v[52:55], v13 offset:1024
  ds_read_b128 v[56:59], v13 offset:2048
  ds_read_b128 v[60:63], v13 offset:3072
  ds_write_b128 v12, v[16:19] offset:0
  ds_write_b128 v12, v[20:23] offset:1024
  ds_write_b128 v12, v[24:27] offset:2048
  ds_write_b128 v12, v[28:31] offset:3072
  ds_read_b128 v[64:67], v13 offset:0
  ds_read_b128 v[68:71], v13 offset:1024
  ds_read_b128 v[72:75], v13 offset:2048
  ds_read_b128 v[76:79], v13 offset:3072
  s_waitcnt lgkmcnt(8)
  v_lshlrev_b32 v14, 16, v80
  v_fmac_f32 v48, v14, v217
  v_and_b32 v14, 0xffff0000, v80
  v_fmac_f32 v49, v14, v217
  v_lshlrev_b32 v14, 16, v81
  v_fmac_f32 v50, v14, v217
  v_and_b32 v14, 0xffff0000, v81
  v_fmac_f32 v51, v14, v217
  v_lshlrev_b32 v14, 16, v82
  v_fmac_f32 v52, v14, v217
  v_and_b32 v14, 0xffff0000, v82
  v_fmac_f32 v53, v14, v217
  v_lshlrev_b32 v14, 16, v83
  v_fmac_f32 v54, v14, v217
  v_and_b32 v14, 0xffff0000, v83
  v_fmac_f32 v55, v14, v217
  v_lshlrev_b32 v14, 16, v84
  v_fmac_f32 v56, v14, v217
  v_and_b32 v14, 0xffff0000, v84
  v_fmac_f32 v57, v14, v217
  v_lshlrev_b32 v14, 16, v85
  v_fmac_f32 v58, v14, v217
  v_and_b32 v14, 0xffff0000, v85
  v_fmac_f32 v59, v14, v217
  v_lshlrev_b32 v14, 16, v86
  v_fmac_f32 v60, v14, v217
  v_and_b32 v14, 0xffff0000, v86
  v_fmac_f32 v61, v14, v217
  v_lshlrev_b32 v14, 16, v87
  v_fmac_f32 v62, v14, v217
  v_and_b32 v14, 0xffff0000, v87
  v_fmac_f32 v63, v14, v217
  s_waitcnt lgkmcnt(3)
  v_add_f32 v48, v48, v64
  v_add_f32 v49, v49, v65
  v_add_f32 v50, v50, v66
  v_add_f32 v51, v51, v67
  v_cvt_pk_bf16_f32 v96, v48, v49
  v_cvt_pk_bf16_f32 v97, v50, v51
  global_store_dwordx2 v15, v[96:97], s[48:49] offset:0 sc1
  s_waitcnt lgkmcnt(2)
  v_add_f32 v52, v52, v68
  v_add_f32 v53, v53, v69
  v_add_f32 v54, v54, v70
  v_add_f32 v55, v55, v71
  v_cvt_pk_bf16_f32 v98, v52, v53
  v_cvt_pk_bf16_f32 v99, v54, v55
  global_store_dwordx2 v15, v[98:99], s[48:49] offset:512 sc1
  s_waitcnt lgkmcnt(1)
  v_add_f32 v56, v56, v72
  v_add_f32 v57, v57, v73
  v_add_f32 v58, v58, v74
  v_add_f32 v59, v59, v75
  v_cvt_pk_bf16_f32 v100, v56, v57
  v_cvt_pk_bf16_f32 v101, v58, v59
  global_store_dwordx2 v15, v[100:101], s[48:49] offset:1024 sc1
  s_waitcnt lgkmcnt(0)
  v_add_f32 v60, v60, v76
  v_add_f32 v61, v61, v77
  v_add_f32 v62, v62, v78
  v_add_f32 v63, v63, v79
  v_cvt_pk_bf16_f32 v102, v60, v61
  v_cvt_pk_bf16_f32 v103, v62, v63
  global_store_dwordx2 v15, v[102:103], s[48:49] offset:1536 sc1
  s_lshl_b32 s11, s68, 12
  s_add_u32 s11, s11, 116736
  v_lshrrev_b32 v23, 2, v0
  v_mul_u32_u24 v23, 72, v23
  v_and_b32 v24, 3, v0
  v_lshl_add_u32 v23, v24, 4, v23
  v_add_u32 v23, s11, v23
  v_lshrrev_b32 v26, 5, v0
  v_mul_u32_u24 v26, 288, v26
  v_and_b32 v24, 31, v0
  v_lshl_add_u32 v26, v24, 1, v26
  v_add_u32 v26, s11, v26
  s_lshl_b32 s11, s68, 2
  s_add_u32 s12, s11, 163440
  v_mov_b32 v12, s12
  v_mov_b32 v13, 1
  s_add_u32 s12, s11, 163472
  v_mov_b32 v21, s12
  v_mov_b32 v14, 163408
  v_mov_b32 v15, 1
  s_waitcnt vmcnt(0)
  s_mov_b64 exec, 1
  ds_add_rtn_u32 v15, v14, v15
  s_mov_b64 exec, -1
  s_lshl_b32 s11, s4, 7
  s_lshl_b32 s12, s5, 2
  s_add_u32 s11, s11, s12
  s_add_u32 s11, s11, 14757888
  v_lshlrev_b32 v16, 14, v0
  v_add_u32 v16, s11, v16
  v_mov_b32 v17, s10
  s_waitcnt lgkmcnt(0)
  v_readfirstlane_b32 s12, v15
  s_nop 0
  s_cmp_eq_u32 s12, 3
  s_cselect_b32 exec_lo, 0xffff, 0
  s_mov_b32 exec_hi, 0
  s_cbranch_execz fy_50
  global_store_dword v16, v17, s[48:49] sc1
fy_50:
  s_mov_b64 exec, -1
  s_setprio 0
  s_mov_b32 s12, 262144
isp_51:
  s_sleep 2
  ds_read_b32 v22, v21
  s_sub_u32 s12, s12, 1
  s_waitcnt lgkmcnt(0)
  v_readfirstlane_b32 s11, v22
  s_nop 0
  s_cselect_b32 s61, -1, s11
  s_cmp_lt_u32 s61, 3
  s_cbranch_scc1 isp_51
  s_setprio 3
  s_lshl_b32 s62, s9, 7
  s_lshl_b32 s11, s68, 14
  s_add_u32 s62, s62, s11
  s_add_u32 s62, s62, 14757888
  s_mov_b32 s63, 4
  s_mov_b32 s60, s10
  s_mov_b32 s61, s10
yl_52:
  s_load_dwordx16 s[16:31], s[48:49], s62
  s_add_u32 s11, s62, 64
  s_load_dwordx16 s[32:47], s[48:49], s11
  s_waitcnt lgkmcnt(0)
  s_xor_b64 s[16:17], s[16:17], s[60:61]
  s_xor_b64 s[18:19], s[18:19], s[60:61]
  s_or_b64 s[16:17], s[16:17], s[18:19]
  s_xor_b64 s[20:21], s[20:21], s[60:61]
  s_or_b64 s[16:17], s[16:17], s[20:21]
  s_xor_b64 s[22:23], s[22:23], s[60:61]
  s_or_b64 s[16:17], s[16:17], s[22:23]
  s_xor_b64 s[24:25], s[24:25], s[60:61]
  s_or_b64 s[16:17], s[16:17], s[24:25]
  s_xor_b64 s[26:27], s[26:27], s[60:61]
  s_or_b64 s[16:17], s[16:17], s[26:27]
  s_xor_b64 s[28:29], s[28:29], s[60:61]
  s_or_b64 s[16:17], s[16:17], s[28:29]
  s_xor_b64 s[30:31], s[30:31], s[60:61]
  s_or_b64 s[16:17], s[16:17], s[30:31]
  s_xor_b64 s[32:33], s[32:33], s[60:61]
  s_or_b64 s[16:17], s[16:17], s[32:33]
  s_xor_b64 s[34:35], s[34:35], s[60:61]
  s_or_b64 s[16:17], s[16:17], s[34:35]
  s_xor_b64 s[36:37], s[36:37], s[60:61]
  s_or_b64 s[16:17], s[16:17], s[36:37]
  s_xor_b64 s[38:39], s[38:39], s[60:61]
  s_or_b64 s[16:17], s[16:17], s[38:39]
  s_xor_b64 s[40:41], s[40:41], s[60:61]
  s_or_b64 s[16:17], s[16:17], s[40:41]
  s_xor_b64 s[42:43], s[42:43], s[60:61]
  s_or_b64 s[16:17], s[16:17], s[42:43]
  s_xor_b64 s[44:45], s[44:45], s[60:61]
  s_or_b64 s[16:17], s[16:17], s[44:45]
  s_xor_b64 s[46:47], s[46:47], s[60:61]
  s_or_b64 s[16:17], s[16:17], s[46:47]
  s_cbranch_scc1 slow_54
back_55:
  s_mov_b32 s11, 12582912
  buffer_load_dwordx4 v[112:115], v216, s[64:67], s11 offen sc1
  s_mov_b32 s11, 12648448
  buffer_load_dwordx4 v[116:119], v216, s[64:67], s11 offen sc1
  s_waitcnt vmcnt(0)
  ds_write_b64 v23, v[112:113] offset:0
  ds_write_b64 v23, v[114:115] offset:8
  ds_write_b64 v23, v[116:117] offset:1152
  ds_write_b64 v23, v[118:119] offset:1160
  ds_read_u16 v80, v26 offset:0
  ds_read_u16 v81, v26 offset:72
  ds_read_u16 v82, v26 offset:144
  ds_read_u16 v83, v26 offset:216
  ds_read_u16 v84, v26 offset:576
  ds_read_u16 v85, v26 offset:648
  ds_read_u16 v86, v26 offset:720
  ds_read_u16 v87, v26 offset:792
  ds_read_u16 v88, v26 offset:1152
  ds_read_u16 v89, v26 offset:1224
  ds_read_u16 v90, v26 offset:1296
  ds_read_u16 v91, v26 offset:1368
  ds_read_u16 v92, v26 offset:1728
  ds_read_u16 v93, v26 offset:1800
  ds_read_u16 v94, v26 offset:1872
  ds_read_u16 v95, v26 offset:1944
  s_waitcnt lgkmcnt(0)
  v_lshlrev_b32 v80, 16, v80
  v_lshlrev_b32 v81, 16, v81
  v_lshlrev_b32 v82, 16, v82
  v_lshlrev_b32 v83, 16, v83
  v_lshlrev_b32 v84, 16, v84
  v_lshlrev_b32 v85, 16, v85
  v_lshlrev_b32 v86, 16, v86
  v_lshlrev_b32 v87, 16, v87
  v_lshlrev_b32 v88, 16, v88
  v_lshlrev_b32 v89, 16, v89
  v_lshlrev_b32 v90, 16, v90
  v_lshlrev_b32 v91, 16, v91
  v_lshlrev_b32 v92, 16, v92
  v_lshlrev_b32 v93, 16, v93
  v_lshlrev_b32 v94, 16, v94
  v_lshlrev_b32 v95, 16, v95
  ds_write_b128 v11, v[80:83] offset:0
  ds_write_b128 v11, v[84:87] offset:1024
  ds_write_b128 v11, v[88:91] offset:2048
  ds_write_b128 v11, v[92:95] offset:3072
  s_waitcnt lgkmcnt(0)
  s_barrier
  s_endpgm
slow_28:
  s_nop 4
  s_sleep 6
  s_load_dword s10, s[92:93], 192
  s_waitcnt lgkmcnt(0)
  s_cmp_lg_u32 s10, 0
  s_cbranch_scc1 nonced_57
  s_mov_b32 s12, 65536
nonce_56:
  s_sleep 4
  global_load_dword v45, v47, s[92:93] offset:128 sc1
  s_waitcnt vmcnt(0)
  v_readfirstlane_b32 s10, v45
  s_nop 1
  s_cmp_lg_u32 s10, 0
  s_cbranch_scc1 nonced_57
  s_sub_u32 s12, s12, 1
  s_cbranch_scc0 nonce_56
nonced_57:
  s_nop 4
  s_branch back_29
slow_30:
  s_nop 4
  s_mov_b32 s12, 65536
rf_58:
  s_sleep 8
  global_load_dwordx2 v[44:45], v40, s[48:49] sc1
  s_waitcnt vmcnt(0)
  v_cmp_ne_u32 vcc, s10, v45
  s_nop 0
  s_cmp_eq_u64 vcc, 0
  s_cbranch_scc1 rfd_59
  s_sub_u32 s12, s12, 1
  s_cbranch_scc0 rf_58
rfd_59:
  s_nop 4
  s_branch back_31
slow_40:
  s_nop 4
  s_lshl_b32 s62, s93, 6
  s_add_u32 s62, s62, 14811136
  s_mov_b32 s63, 7
  s_lshl_b32 s11, s68, 14
  s_add_u32 s62, s62, s11
sw_60:
  s_load_dword s60, s[48:49], s62
  s_waitcnt lgkmcnt(0)
  s_cmp_eq_u32 s60, s10
  s_cbranch_scc1 swd_61
  s_sleep 4
  s_add_u32 s62, s62, 65536
  s_sub_u32 s63, s63, 1
  s_cmp_lg_u32 s63, 0
  s_cbranch_scc1 sw_60
  s_sub_u32 s62, s62, 65536
  v_mov_b32 v26, s62
  s_mov_b32 s12, 65536
poll_62:
  global_load_dword v27, v26, s[48:49] sc1
  s_waitcnt vmcnt(0)
  v_cmp_ne_u32 vcc, s10, v27
  s_nop 0
  s_cmp_eq_u64 vcc, 0
  s_cbranch_scc1 polld_63
  s_sleep 4
  s_sub_u32 s12, s12, 1
  s_cbranch_scc0 poll_62
polld_63:
swd_61:
  global_load_dwordx4 v[192:195], v219, s[48:49] sc1
  global_load_dwordx4 v[196:199], v245, s[48:49] sc1
  s_nop 4
  s_branch back_41
slow_42:
  s_nop 4
  s_mov_b32 s12, 65536
rg_64:
  s_sleep 8
  s_add_u32 m0, s101, 0
  s_add_u32 s11, s100, 0
  buffer_load_dwordx4 v46, s[64:67], s11 offen sc1 lds
  s_add_u32 m0, s101, 1024
  s_add_u32 s11, s100, 1024
  buffer_load_dwordx4 v46, s[64:67], s11 offen sc1 lds
  s_add_u32 m0, s101, 2048
  s_add_u32 s11, s100, 2048
  buffer_load_dwordx4 v46, s[64:67], s11 offen sc1 lds
  s_add_u32 m0, s101, 3072
  s_add_u32 s11, s100, 3072
  buffer_load_dwordx4 v46, s[64:67], s11 offen sc1 lds
  s_waitcnt vmcnt(0)
  ds_read_b128 v[200:203], v218 offset:0
  ds_read_b128 v[204:207], v218 offset:16
  ds_read_b128 v[208:211], v218 offset:32
  ds_read_b128 v[212:215], v218 offset:48
  s_waitcnt lgkmcnt(0)
  v_xor_b32 v26, s10, v201
  v_xor_b32 v27, s10, v203
  v_or_b32 v26, v26, v27
  v_xor_b32 v27, s10, v205
  v_or_b32 v26, v26, v27
  v_xor_b32 v27, s10, v207
  v_or_b32 v26, v26, v27
  v_xor_b32 v27, s10, v209
  v_or_b32 v26, v26, v27
  v_xor_b32 v27, s10, v211
  v_or_b32 v26, v26, v27
  v_xor_b32 v27, s10, v213
  v_or_b32 v26, v26, v27
  v_xor_b32 v27, s10, v215
  v_or_b32 v26, v26, v27
  v_cmp_ne_u32 vcc, 0, v26
  s_nop 0
  s_cmp_eq_u64 vcc, 0
  s_cbranch_scc1 rgd_65
  s_sub_u32 s12, s12, 1
  s_cbranch_scc0 rg_64
rgd_65:
  s_nop 4
  s_branch back_43
slow_54:
  s_nop 4
  s_sleep 6
  s_add_u32 s62, s62, 65536
  s_sub_u32 s63, s63, 1
  s_cmp_lg_u32 s63, 0
  s_cbranch_scc1 yl_52
  s_sub_u32 s62, s62, 65536
  v_and_b32 v18, 31, v0
  v_lshlrev_b32 v18, 2, v18
  v_add_u32 v18, s62, v18
  s_mov_b32 s12, 65536
poll_66:
  global_load_dword v19, v18, s[48:49] sc1
  s_waitcnt vmcnt(0)
  v_cmp_ne_u32 vcc, s10, v19
  s_nop 0
  s_cmp_eq_u64 vcc, 0
  s_cbranch_scc1 polld_67
  s_sleep 12
  s_sub_u32 s12, s12, 1
  s_cbranch_scc0 poll_66
polld_67:
  s_nop 4
  s_branch back_55
L_XA:
  s_setprio 3
  s_mul_i32 s11, s68, 4352
  s_add_u32 s11, s11, 143936
  v_lshlrev_b32 v106, 2, v0
  v_add_u32 v118, s11, v106
  v_add_u32 v119, 1088, v118
  v_add_u32 v120, 2176, v118
  v_add_u32 v121, 3264, v118
  v_and_b32 v106, 15, v0
  v_mul_u32_u24 v106, 272, v106
  v_lshrrev_b32 v107, 4, v0
  v_lshl_add_u32 v106, v107, 4, v106
  v_add_u32 v122, s11, v106
  v_lshlrev_b32 v106, 4, v0
  v_add_u32 v123, s11, v106
  s_lshl_b32 s11, s99, 8
  s_lshl_b32 s12, s98, 7
  s_add_u32 s11, s11, s12
  v_lshlrev_b32 v106, 1, v0
  v_add_u32 v106, s11, v106
  s_lshl_b32 s11, s99, 1
  v_mov_b32 v107, s11
  v_lshlrev_b32 v23, 2, v0
  v_add_u32 v23, 163392, v23
  ds_write_b32 v23, v47
  v_mov_b32 v23, 141062
  ds_write_b16 v23, v47
  ds_write_b16 v23, v47 offset:2832
  v_mov_b32 v47, 0
  v_lshlrev_b32 v46, 4, v0
  s_lshl_b32 s11, s4, 8
  s_lshl_b32 s12, s5, 3
  s_add_u32 s11, s11, s12
  s_lshl_b32 s12, s68, 1
  s_add_u32 s13, s11, s12
  v_lshrrev_b32 v21, 5, v0
  v_add_u32 v21, s13, v21
  v_and_b32 v22, 31, v0
  v_lshlrev_b32 v22, 4, v22
  v_lshl_add_u32 v22, v21, 10, v22
  v_lshlrev_b32 v39, 3, v21
  v_add_u32 v39, 14680064, v39
  v_lshrrev_b32 v17, 5, v0
  v_bfe_u32 v45, v0, 2, 2
  v_lshl_add_u32 v17, v17, 2, v45
  v_lshlrev_b32 v17, 6, v17
  v_bfe_u32 v45, v0, 4, 1
  v_lshl_add_u32 v17, v45, 5, v17
  v_and_b32 v45, 3, v0
  v_lshl_add_u32 v17, v45, 3, v17
  s_waitcnt lgkmcnt(0)
  global_load_dwordx4 v[48:51], v22, s[16:17]
  global_load_dwordx4 v[52:55], v22, s[16:17] offset:512
  s_mov_b32 s60, s40
  s_and_b32 s61, s41, 0xffff
  s_mov_b32 s62, 1835008
  s_mov_b32 s63, 0x00020000
  v_lshrrev_b32 v19, 2, v0
  v_and_b32 v20, 3, v0
  v_lshlrev_b32 v20, 4, v20
  v_lshl_add_u32 v19, v19, 10, v20
  s_and_b32 s11, s5, 1
  s_lshl_b32 s12, s4, 1
  s_add_u32 s50, s11, s12
  s_lshr_b32 s11, s5, 1
  s_mul_i32 s51, s11, 7
  s_lshl_b32 s11, s68, 1
  s_add_u32 s11, s11, 0
  s_min_u32 s100, s11, 6
  s_lshl_b32 s11, s100, 10
  s_add_u32 m0, s11, 131072
  s_add_u32 s11, s51, s100
  s_lshl_b32 s11, s11, 14
  s_lshl_b32 s12, s50, 6
  s_add_u32 s11, s11, s12
  buffer_load_dwordx4 v19, s[60:63], s11 offen lds
  s_lshl_b32 s11, s68, 1
  s_add_u32 s11, s11, 1
  s_min_u32 s101, s11, 6
  s_lshl_b32 s11, s101, 10
  s_add_u32 m0, s11, 131072
  s_add_u32 s11, s51, s101
  s_lshl_b32 s11, s11, 14
  s_lshl_b32 s12, s50, 6
  s_add_u32 s11, s11, s12
  buffer_load_dwordx4 v19, s[60:63], s11 offen lds
  s_mov_b32 s64, s48
  s_and_b32 s65, s49, 0xffff
  s_mov_b32 s66, 268435456
  s_mov_b32 s67, 0x00020000
  s_mov_b32 s92, s46
  s_mov_b32 s93, s47
  global_load_ushort v96, v106, s[18:19]
  global_load_ushort v97, v106, s[20:21]
  global_load_ushort v98, v106, s[22:23]
  global_load_ushort v99, v106, s[24:25]
  global_load_ushort v100, v106, s[26:27]
  global_load_ushort v101, v106, s[28:29]
  global_load_ushort v102, v107, s[30:31]
  s_barrier
  s_waitcnt vmcnt(9)
  s_load_dword s10, s[92:93], 0
  v_lshlrev_b32 v56, 16, v48
  v_and_b32 v57, 0xffff0000, v48
  v_lshlrev_b32 v58, 16, v49
  v_and_b32 v59, 0xffff0000, v49
  v_lshlrev_b32 v60, 16, v50
  v_and_b32 v61, 0xffff0000, v50
  v_lshlrev_b32 v62, 16, v51
  v_and_b32 v63, 0xffff0000, v51
  v_lshlrev_b32 v64, 16, v52
  v_and_b32 v65, 0xffff0000, v52
  v_lshlrev_b32 v66, 16, v53
  v_and_b32 v67, 0xffff0000, v53
  v_lshlrev_b32 v68, 16, v54
  v_and_b32 v69, 0xffff0000, v54
  v_lshlrev_b32 v70, 16, v55
  v_and_b32 v71, 0xffff0000, v55
  v_add_f32 v72, v56, v57
  v_add_f32 v73, v58, v59
  v_add_f32 v72, v72, v60
  v_add_f32 v73, v73, v61
  v_add_f32 v72, v72, v62
  v_add_f32 v73, v73, v63
  v_add_f32 v72, v72, v64
  v_add_f32 v73, v73, v65
  v_add_f32 v72, v72, v66
  v_add_f32 v73, v73, v67
  v_add_f32 v72, v72, v68
  v_add_f32 v73, v73, v69
  v_add_f32 v72, v72, v70
  v_add_f32 v73, v73, v71
  v_add_f32 v72, v72, v73
  s_nop 1
  v_add_f32_dpp v72, v72, v72 quad_perm:[1,0,3,2] row_mask:0xf bank_mask:0xf
  s_nop 1
  v_add_f32_dpp v72, v72, v72 quad_perm:[2,3,0,1] row_mask:0xf bank_mask:0xf
  s_nop 1
  v_add_f32_dpp v72, v72, v72 row_half_mirror row_mask:0xf bank_mask:0xf
  s_nop 1
  v_add_f32_dpp v72, v72, v72 row_mirror row_mask:0xf bank_mask:0xf
  v_mov_b32 v73, v72
  s_nop 1
  v_permlane16_swap_b32 v72, v73
  v_add_f32 v72, v72, v73
  v_mul_f32 v72, 0x3b000000, v72
  v_cvt_pk_bf16_f32 v74, v72, v72
  v_lshlrev_b32 v74, 16, v74
  v_sub_f32 v73, v72, v74
  v_sub_f32 v56, v56, v74
  v_sub_f32 v57, v57, v74
  v_sub_f32 v58, v58, v74
  v_sub_f32 v59, v59, v74
  v_sub_f32 v60, v60, v74
  v_sub_f32 v61, v61, v74
  v_sub_f32 v62, v62, v74
  v_sub_f32 v63, v63, v74
  v_sub_f32 v64, v64, v74
  v_sub_f32 v65, v65, v74
  v_sub_f32 v66, v66, v74
  v_sub_f32 v67, v67, v74
  v_sub_f32 v68, v68, v74
  v_sub_f32 v69, v69, v74
  v_sub_f32 v70, v70, v74
  v_sub_f32 v71, v71, v74
  v_mul_f32 v76, v56, v56
  v_mul_f32 v77, v57, v57
  v_fmac_f32 v76, v58, v58
  v_fmac_f32 v77, v59, v59
  v_fmac_f32 v76, v60, v60
  v_fmac_f32 v77, v61, v61
  v_fmac_f32 v76, v62, v62
  v_fmac_f32 v77, v63, v63
  v_fmac_f32 v76, v64, v64
  v_fmac_f32 v77, v65, v65
  v_fmac_f32 v76, v66, v66
  v_fmac_f32 v77, v67, v67
  v_fmac_f32 v76, v68, v68
  v_fmac_f32 v77, v69, v69
  v_fmac_f32 v76, v70, v70
  v_fmac_f32 v77, v71, v71
  v_add_f32 v76, v76, v77
  s_nop 1
  v_add_f32_dpp v76, v76, v76 quad_perm:[1,0,3,2] row_mask:0xf bank_mask:0xf
  s_nop 1
  v_add_f32_dpp v76, v76, v76 quad_perm:[2,3,0,1] row_mask:0xf bank_mask:0xf
  s_nop 1
  v_add_f32_dpp v76, v76, v76 row_half_mirror row_mask:0xf bank_mask:0xf
  s_nop 1
  v_add_f32_dpp v76, v76, v76 row_mirror row_mask:0xf bank_mask:0xf
  v_mov_b32 v77, v76
  s_nop 1
  v_permlane16_swap_b32 v76, v77
  v_add_f32 v76, v76, v77
  v_mul_f32 v76, 0x3b000000, v76
  v_fma_f32 v76, -v73, v73, v76
  v_max_f32 v76, 0, v76
  v_cvt_pk_bf16_f32 v76, v76, v76
  v_lshlrev_b32 v76, 16, v76
  v_add_f32 v76, 0x3727c5ac, v76
  v_cvt_pk_bf16_f32 v76, v76, v76
  v_lshlrev_b32 v76, 16, v76
  v_sqrt_f32 v76, v76
  s_nop 0
  v_cvt_pk_bf16_f32 v36, v72, v76
  s_waitcnt lgkmcnt(0)
  s_cmp_eq_u32 s10, 0
  s_cbranch_scc1 slow_68
back_69:
  v_mov_b32 v37, s10
  s_mov_b32 exec_lo, 1
  s_mov_b32 exec_hi, 1
  global_store_dwordx2 v39, v[36:37], s[48:49] sc1
  s_mov_b64 exec, -1
  s_waitcnt vmcnt(8)
  s_lshl_b32 s11, s100, 10
  s_add_u32 s11, s11, 131072
  v_add_u32 v16, s11, v17
  ds_read_b64_tr_b16 v[80:81], v16 offset:0
  ds_read_b64_tr_b16 v[82:83], v16 offset:512
  s_lshl_b32 s11, s101, 10
  s_add_u32 s11, s11, 131072
  v_add_u32 v16, s11, v17
  ds_read_b64_tr_b16 v[84:85], v16 offset:0
  ds_read_b64_tr_b16 v[86:87], v16 offset:512
  s_waitcnt lgkmcnt(0)
  s_mul_i32 s11, s50, 112
  s_add_u32 s11, s11, s51
  s_add_u32 s11, s11, s100
  s_lshl_b32 s11, s11, 10
  s_add_u32 s11, s11, 8388608
  buffer_store_dwordx4 v[80:83], v46, s[64:67], s11 offen sc1
  s_mul_i32 s11, s50, 112
  s_add_u32 s11, s11, s51
  s_add_u32 s11, s11, s101
  s_lshl_b32 s11, s11, 10
  s_add_u32 s11, s11, 8388608
  buffer_store_dwordx4 v[84:87], v46, s[64:67], s11 offen sc1
  s_load_dword s10, s[92:93], 128
  s_lshl_b32 s11, s7, 8
  s_lshl_b32 s12, s68, 6
  s_add_u32 s11, s11, s12
  v_and_b32 v24, 15, v0
  v_lshlrev_b32 v25, 2, v24
  v_add_u32 v25, s11, v25
  global_load_dword v42, v25, s[38:39]
  s_lshl_b32 s11, s99, 1
  v_mov_b32 v18, s11
  global_load_ushort v217, v18, s[32:33]
  s_and_b32 s11, s68, 1
  s_lshl_b32 s11, s11, 6
  s_lshl_b32 s12, s8, 7
  s_add_u32 s11, s11, s12
  v_and_b32 v26, 3, v0
  v_lshlrev_b32 v26, 4, v26
  v_add_u32 v26, s11, v26
  s_lshr_b32 s11, s68, 1
  s_lshl_b32 s11, s11, 5
  s_lshl_b32 s12, s9, 6
  s_add_u32 s11, s11, s12
  v_lshrrev_b32 v27, 2, v0
  v_add_u32 v27, s11, v27
  v_lshl_add_u32 v216, v27, 12, v26
  s_waitcnt lgkmcnt(0)
  s_cmp_eq_u32 s10, 0
  s_cbranch_scc1 slow_70
back_71:
  v_mov_b32 v16, 163392
  ds_write_b32 v16, v37
  s_lshl_b32 s94, s4, 2
  s_lshr_b32 s11, s5, 3
  s_add_u32 s94, s94, s11
  s_add_u32 s94, s94, 137
  s_waitcnt vmcnt(2)
  s_lshl_b32 s11, s94, 7
  s_add_u32 s11, s11, 15269888
  v_mov_b32 v184, s11
  v_mov_b32 v185, 1
  s_mov_b64 exec, 1
  global_atomic_add v185, v184, v185, s[48:49] sc0 sc1
  s_mov_b64 exec, -1
  s_setprio 1
  s_mul_i32 s11, s68, 4352
  s_lshl_b32 s12, s98, 11
  s_add_u32 s11, s11, s12
  s_add_u32 s11, s11, 143936
  v_add_u32 v246, s11, v46
  s_xor_b32 s11, s68, 1
  s_mul_i32 s11, s11, 4352
  s_add_u32 s11, s11, s12
  s_add_u32 s11, s11, 143936
  v_add_u32 v247, s11, v46
  s_lshl_b32 s11, s68, 2
  s_add_u32 s11, s11, 163424
  v_mov_b32 v188, s11
  v_xor_b32 v189, 4, v188
  v_and_b32 v18, 15, v0
  v_lshlrev_b32 v19, 1, v18
  v_add_u32 v19, 240, v19
  v_bfe_u32 v20, v18, 1, 1
  v_lshlrev_b32 v20, 8, v20
  v_and_b32 v21, 1, v18
  v_lshl_add_u32 v20, v21, 2, v20
  v_add_u32 v20, 512, v20
  v_cmp_gt_u32 vcc, 8, v18
  s_nop 1
  v_cndmask_b32 v19, v19, v18, vcc
  v_cmp_lt_u32 vcc, 11, v18
  s_nop 1
  v_cndmask_b32 v19, v19, v20, vcc
  v_lshlrev_b32 v20, 8, v18
  v_add_u32 v20, 1024, v20
  v_lshrrev_b32 v21, 4, v0
  v_lshlrev_b32 v21, 5, v21
  s_lshl_b32 s11, s98, 7
  v_add_u32 v21, s11, v21
  v_add_u32 v19, v19, v21
  v_add_u32 v20, v20, v21
  s_mul_i32 s11, s69, 2832
  s_add_u32 s11, s11, 105730
  v_mov_b32 v22, s11
  v_mov_b32 v23, 17665
  s_mov_b32 s12, 16255
  v_lshlrev_b32 v25, 2, v0
  v_add_u32 v25, 163584, v25
  v_add_u32 v24, 0, v19
  v_cvt_f32_u32 v24, v24
  v_add_u32 v24, 0xffff, v24
  v_lshrrev_b32 v24, 16, v24
  v_med3_u32 v24, v24, s12, v23
  v_lshl_add_u32 v220, v24, 1, v22
  v_add_u32 v24, 8, v19
  v_cvt_f32_u32 v24, v24
  v_add_u32 v24, 0xffff, v24
  v_lshrrev_b32 v24, 16, v24
  v_med3_u32 v24, v24, s12, v23
  v_lshl_add_u32 v221, v24, 1, v22
  v_add_u32 v24, 16, v19
  v_cvt_f32_u32 v24, v24
  v_add_u32 v24, 0xffff, v24
  v_lshrrev_b32 v24, 16, v24
  v_med3_u32 v24, v24, s12, v23
  v_lshl_add_u32 v222, v24, 1, v22
  v_add_u32 v24, 24, v19
  v_cvt_f32_u32 v24, v24
  v_add_u32 v24, 0xffff, v24
  v_lshrrev_b32 v24, 16, v24
  v_med3_u32 v24, v24, s12, v23
  v_lshl_add_u32 v223, v24, 1, v22
  v_add_u32 v24, 0, v20
  v_cvt_f32_u32 v24, v24
  v_add_u32 v24, 0xffff, v24
  v_lshrrev_b32 v24, 16, v24
  v_med3_u32 v24, v24, s12, v23
  v_lshl_add_u32 v224, v24, 1, v22
  v_cmp_eq_u32 vcc, v24, v23
  s_nop 1
  v_cndmask_b32 v224, v224, v25, vcc
  v_add_u32 v24, 8, v20
  v_cvt_f32_u32 v24, v24
  v_add_u32 v24, 0xffff, v24
  v_lshrrev_b32 v24, 16, v24
  v_med3_u32 v24, v24, s12, v23
  v_lshl_add_u32 v225, v24, 1, v22
  v_cmp_eq_u32 vcc, v24, v23
  s_nop 1
  v_cndmask_b32 v225, v225, v25, vcc
  v_add_u32 v24, 16, v20
  v_cvt_f32_u32 v24, v24
  v_add_u32 v24, 0xffff, v24
  v_lshrrev_b32 v24, 16, v24
  v_med3_u32 v24, v24, s12, v23
  v_lshl_add_u32 v226, v24, 1, v22
  v_cmp_eq_u32 vcc, v24, v23
  s_nop 1
  v_cndmask_b32 v226, v226, v25, vcc
  v_add_u32 v24, 24, v20
  v_cvt_f32_u32 v24, v24
  v_add_u32 v24, 0xffff, v24
  v_lshrrev_b32 v24, 16, v24
  v_med3_u32 v24, v24, s12, v23
  v_lshl_add_u32 v227, v24, 1, v22
  v_cmp_eq_u32 vcc, v24, v23
  s_nop 1
  v_cndmask_b32 v227, v227, v25, vcc
  s_lshl_b32 s11, s98, 10
  v_add_u32 v18, s11, v46
  v_sub_u32 v19, 2047, v18
  v_cvt_f32_i32 v19, v19
  v_mov_b32 v23, 17666
  v_subrev_f32 v20, 0x00000000, v19
  v_subrev_f32 v21, 0x3f800000, v19
  v_cvt_pk_bf16_f32 v20, v20, v21
  v_and_b32 v21, 0xffff, v20
  v_med3_u32 v21, v21, s12, v23
  v_lshl_add_u32 v228, v21, 1, v22
  v_lshrrev_b32 v20, 16, v20
  v_med3_u32 v20, v20, s12, v23
  v_lshl_add_u32 v229, v20, 1, v22
  v_subrev_f32 v20, 0x40000000, v19
  v_subrev_f32 v21, 0x40400000, v19
  v_cvt_pk_bf16_f32 v20, v20, v21
  v_and_b32 v21, 0xffff, v20
  v_med3_u32 v21, v21, s12, v23
  v_lshl_add_u32 v230, v21, 1, v22
  v_lshrrev_b32 v20, 16, v20
  v_med3_u32 v20, v20, s12, v23
  v_lshl_add_u32 v231, v20, 1, v22
  v_subrev_f32 v20, 0x40800000, v19
  v_subrev_f32 v21, 0x40a00000, v19
  v_cvt_pk_bf16_f32 v20, v20, v21
  v_and_b32 v21, 0xffff, v20
  v_med3_u32 v21, v21, s12, v23
  v_lshl_add_u32 v232, v21, 1, v22
  v_lshrrev_b32 v20, 16, v20
  v_med3_u32 v20, v20, s12, v23
  v_lshl_add_u32 v233, v20, 1, v22
  v_subrev_f32 v20, 0x40c00000, v19
  v_subrev_f32 v21, 0x40e00000, v19
  v_cvt_pk_bf16_f32 v20, v20, v21
  v_and_b32 v21, 0xffff, v20
  v_med3_u32 v21, v21, s12, v23
  v_lshl_add_u32 v234, v21, 1, v22
  v_lshrrev_b32 v20, 16, v20
  v_med3_u32 v20, v20, s12, v23
  v_lshl_add_u32 v235, v20, 1, v22
  v_subrev_f32 v20, 0x41000000, v19
  v_subrev_f32 v21, 0x41100000, v19
  v_cvt_pk_bf16_f32 v20, v20, v21
  v_and_b32 v21, 0xffff, v20
  v_med3_u32 v21, v21, s12, v23
  v_lshl_add_u32 v236, v21, 1, v22
  v_lshrrev_b32 v20, 16, v20
  v_med3_u32 v20, v20, s12, v23
  v_lshl_add_u32 v237, v20, 1, v22
  v_subrev_f32 v20, 0x41200000, v19
  v_subrev_f32 v21, 0x41300000, v19
  v_cvt_pk_bf16_f32 v20, v20, v21
  v_and_b32 v21, 0xffff, v20
  v_med3_u32 v21, v21, s12, v23
  v_lshl_add_u32 v238, v21, 1, v22
  v_lshrrev_b32 v20, 16, v20
  v_med3_u32 v20, v20, s12, v23
  v_lshl_add_u32 v239, v20, 1, v22
  v_subrev_f32 v20, 0x41400000, v19
  v_subrev_f32 v21, 0x41500000, v19
  v_cvt_pk_bf16_f32 v20, v20, v21
  v_and_b32 v21, 0xffff, v20
  v_med3_u32 v21, v21, s12, v23
  v_lshl_add_u32 v240, v21, 1, v22
  v_lshrrev_b32 v20, 16, v20
  v_med3_u32 v20, v20, s12, v23
  v_lshl_add_u32 v241, v20, 1, v22
  v_subrev_f32 v20, 0x41600000, v19
  v_subrev_f32 v21, 0x41700000, v19
  v_cvt_pk_bf16_f32 v20, v20, v21
  v_and_b32 v21, 0xffff, v20
  v_med3_u32 v21, v21, s12, v23
  v_lshl_add_u32 v242, v21, 1, v22
  v_lshrrev_b32 v20, 16, v20
  v_med3_u32 v20, v20, s12, v23
  v_lshl_add_u32 v243, v20, 1, v22
  v_subrev_f32 v20, 0x41800000, v19
  v_subrev_f32 v21, 0x41880000, v19
  v_cvt_pk_bf16_f32 v20, v20, v21
  v_and_b32 v21, 0xffff, v20
  v_med3_u32 v21, v21, s12, v23
  v_lshl_add_u32 v244, v21, 1, v22
  s_mul_i32 s95, s69, 8704
  s_add_u32 s95, s95, 143936
  v_lshlrev_b32 v248, 1, v18
  v_add_u32 v248, s95, v248
  v_and_b32 v249, 7, v0
  v_lshlrev_b32 v249, 2, v249
  v_add_u32 v249, s95, v249
  s_waitcnt vmcnt(0)
  v_readfirstlane_b32 s12, v185
  s_nop 0
  s_cmp_eq_u32 s12, 31
  s_cbranch_scc1 cond_72
back_73:
  v_mov_b32 v185, 0
  v_lshlrev_b32 v96, 16, v96
  v_lshlrev_b32 v97, 16, v97
  v_lshlrev_b32 v98, 16, v98
  v_lshlrev_b32 v99, 16, v99
  v_lshlrev_b32 v100, 16, v100
  v_lshlrev_b32 v101, 16, v101
  v_lshlrev_b32 v102, 16, v102
  v_mul_f32 v102, 0x3fb8aa3b, v102
  v_exp_f32 v102, v102
  s_nop 0
  v_cvt_pk_bf16_f32 v102, v102, v102
  v_lshlrev_b32 v102, 16, v102
  v_mul_f32 v104, v102, v96
  v_mul_f32 v105, v102, v97
  v_mul_f32 v104, 0x3fb8aa3b, v104
  v_mul_f32 v105, 0x3e22f983, v105
  v_mul_f32 v98, v102, v98
  v_mul_f32 v99, v102, v99
  v_mul_f32 v106, v101, v99
  v_mul_f32 v107, v101, v98
  v_fma_f32 v96, v100, v98, -v106
  v_fma_f32 v97, v100, v99, v107
  v_sub_f32 v97, 0, v97
  v_mul_f32 v106, 0x3f800000, v104
  v_mul_f32 v107, 0x3f800000, v105
  v_exp_f32 v106, v106
  v_fract_f32 v107, v107
  v_cos_f32 v98, v107
  v_sin_f32 v99, v107
  v_mul_f32 v98, v106, v98
  v_mul_f32 v99, v106, v99
  v_mul_f32 v106, 0x43800000, v104
  v_mul_f32 v107, 0x43800000, v105
  v_exp_f32 v106, v106
  v_fract_f32 v107, v107
  v_cos_f32 v114, v107
  v_sin_f32 v115, v107
  v_mul_f32 v114, v106, v114
  v_mul_f32 v115, v106, v115
  v_mov_b32 v124, 0x3f80
  v_cvt_pk_bf16_f32 v125, v98, v99
  v_mul_f32 v106, v99, v99
  v_mul_f32 v107, v99, v98
  v_fma_f32 v100, v98, v98, -v106
  v_fma_f32 v101, v98, v99, v107
  v_cvt_pk_bf16_f32 v126, v100, v101
  v_mul_f32 v106, v101, v99
  v_mul_f32 v107, v101, v98
  v_fma_f32 v110, v100, v98, -v106
  v_fma_f32 v111, v100, v99, v107
  v_cvt_pk_bf16_f32 v127, v110, v111
  v_mul_f32 v106, v101, v101
  v_mul_f32 v107, v101, v100
  v_fma_f32 v102, v100, v100, -v106
  v_fma_f32 v103, v100, v101, v107
  v_cvt_pk_bf16_f32 v128, v102, v103
  v_mul_f32 v106, v103, v99
  v_mul_f32 v107, v103, v98
  v_fma_f32 v110, v102, v98, -v106
  v_fma_f32 v111, v102, v99, v107
  v_cvt_pk_bf16_f32 v129, v110, v111
  v_mul_f32 v106, v103, v101
  v_mul_f32 v107, v103, v100
  v_fma_f32 v108, v102, v100, -v106
  v_fma_f32 v109, v102, v101, v107
  v_cvt_pk_bf16_f32 v130, v108, v109
  v_mul_f32 v106, v109, v99
  v_mul_f32 v107, v109, v98
  v_fma_f32 v110, v108, v98, -v106
  v_fma_f32 v111, v108, v99, v107
  v_cvt_pk_bf16_f32 v131, v110, v111
  v_cvt_pk_bf16_f32 v132, v114, v115
  v_mul_f32 v106, v115, v101
  v_mul_f32 v107, v115, v100
  v_fma_f32 v110, v114, v100, -v106
  v_fma_f32 v111, v114, v101, v107
  v_cvt_pk_bf16_f32 v133, v110, v111
  v_mul_f32 v106, v115, v103
  v_mul_f32 v107, v115, v102
  v_fma_f32 v110, v114, v102, -v106
  v_fma_f32 v111, v114, v103, v107
  v_cvt_pk_bf16_f32 v134, v110, v111
  v_mul_f32 v106, v115, v109
  v_mul_f32 v107, v115, v108
  v_fma_f32 v110, v114, v108, -v106
  v_fma_f32 v111, v114, v109, v107
  v_cvt_pk_bf16_f32 v135, v110, v111
  v_mul_f32 v106, v115, v115
  v_mul_f32 v107, v115, v114
  v_fma_f32 v116, v114, v114, -v106
  v_fma_f32 v117, v114, v115, v107
  v_cvt_pk_bf16_f32 v136, v116, v117
  v_mul_f32 v106, v117, v103
  v_mul_f32 v107, v117, v102
  v_fma_f32 v110, v116, v102, -v106
  v_fma_f32 v111, v116, v103, v107
  v_cvt_pk_bf16_f32 v137, v110, v111
  v_mul_f32 v106, v117, v115
  v_mul_f32 v107, v117, v114
  v_fma_f32 v112, v116, v114, -v106
  v_fma_f32 v113, v116, v115, v107
  v_cvt_pk_bf16_f32 v138, v112, v113
  v_mul_f32 v106, v113, v103
  v_mul_f32 v107, v113, v102
  v_fma_f32 v110, v112, v102, -v106
  v_fma_f32 v111, v112, v103, v107
  v_cvt_pk_bf16_f32 v139, v110, v111
  v_mul_f32 v106, v117, v117
  v_mul_f32 v107, v117, v116
  v_fma_f32 v110, v116, v116, -v106
  v_fma_f32 v111, v116, v117, v107
  v_cvt_pk_bf16_f32 v140, v110, v111
  v_mul_f32 v106, v111, v115
  v_mul_f32 v107, v111, v114
  v_fma_f32 v112, v110, v114, -v106
  v_fma_f32 v113, v110, v115, v107
  v_cvt_pk_bf16_f32 v141, v112, v113
  v_mul_f32 v106, v113, v115
  v_mul_f32 v107, v113, v114
  v_fma_f32 v110, v112, v114, -v106
  v_fma_f32 v111, v112, v115, v107
  v_cvt_pk_bf16_f32 v142, v110, v111
  v_mul_f32 v106, v111, v115
  v_mul_f32 v107, v111, v114
  v_fma_f32 v112, v110, v114, -v106
  v_fma_f32 v113, v110, v115, v107
  v_cvt_pk_bf16_f32 v143, v112, v113
  v_mul_f32 v106, v113, v115
  v_mul_f32 v107, v113, v114
  v_fma_f32 v110, v112, v114, -v106
  v_fma_f32 v111, v112, v115, v107
  v_cvt_pk_bf16_f32 v144, v110, v111
  v_mul_f32 v106, 0x41000000, v104
  v_mul_f32 v107, 0xc1000000, v105
  v_exp_f32 v106, v106
  v_fract_f32 v107, v107
  v_cos_f32 v98, v107
  v_sin_f32 v99, v107
  v_mul_f32 v98, v106, v98
  v_mul_f32 v99, v106, v99
  v_cvt_pk_bf16_f32 v146, v96, v97
  v_mul_f32 v106, v97, v99
  v_mul_f32 v107, v97, v98
  v_fma_f32 v112, v96, v98, -v106
  v_fma_f32 v113, v96, v99, v107
  v_cvt_pk_bf16_f32 v147, v112, v113
  v_mul_f32 v106, v113, v99
  v_mul_f32 v107, v113, v98
  v_fma_f32 v110, v112, v98, -v106
  v_fma_f32 v111, v112, v99, v107
  v_cvt_pk_bf16_f32 v148, v110, v111
  v_mul_f32 v106, v111, v99
  v_mul_f32 v107, v111, v98
  v_fma_f32 v112, v110, v98, -v106
  v_fma_f32 v113, v110, v99, v107
  v_cvt_pk_bf16_f32 v149, v112, v113
  v_mul_f32 v106, v113, v99
  v_mul_f32 v107, v113, v98
  v_fma_f32 v110, v112, v98, -v106
  v_fma_f32 v111, v112, v99, v107
  v_cvt_pk_bf16_f32 v150, v110, v111
  v_mul_f32 v106, v111, v99
  v_mul_f32 v107, v111, v98
  v_fma_f32 v112, v110, v98, -v106
  v_fma_f32 v113, v110, v99, v107
  v_cvt_pk_bf16_f32 v151, v112, v113
  v_mul_f32 v106, v113, v99
  v_mul_f32 v107, v113, v98
  v_fma_f32 v110, v112, v98, -v106
  v_fma_f32 v111, v112, v99, v107
  v_cvt_pk_bf16_f32 v152, v110, v111
  v_mul_f32 v106, v111, v99
  v_mul_f32 v107, v111, v98
  v_fma_f32 v112, v110, v98, -v106
  v_fma_f32 v113, v110, v99, v107
  v_cvt_pk_bf16_f32 v153, v112, v113
  v_mul_f32 v106, v113, v99
  v_mul_f32 v107, v113, v98
  v_fma_f32 v110, v112, v98, -v106
  v_fma_f32 v111, v112, v99, v107
  v_cvt_pk_bf16_f32 v154, v110, v111
  v_mul_f32 v106, v111, v99
  v_mul_f32 v107, v111, v98
  v_fma_f32 v112, v110, v98, -v106
  v_fma_f32 v113, v110, v99, v107
  v_cvt_pk_bf16_f32 v155, v112, v113
  v_mul_f32 v106, v113, v99
  v_mul_f32 v107, v113, v98
  v_fma_f32 v110, v112, v98, -v106
  v_fma_f32 v111, v112, v99, v107
  v_cvt_pk_bf16_f32 v156, v110, v111
  v_mul_f32 v106, v111, v99
  v_mul_f32 v107, v111, v98
  v_fma_f32 v112, v110, v98, -v106
  v_fma_f32 v113, v110, v99, v107
  v_cvt_pk_bf16_f32 v157, v112, v113
  v_mul_f32 v106, v113, v99
  v_mul_f32 v107, v113, v98
  v_fma_f32 v110, v112, v98, -v106
  v_fma_f32 v111, v112, v99, v107
  v_cvt_pk_bf16_f32 v158, v110, v111
  v_mul_f32 v106, v111, v99
  v_mul_f32 v107, v111, v98
  v_fma_f32 v112, v110, v98, -v106
  v_fma_f32 v113, v110, v99, v107
  v_cvt_pk_bf16_f32 v159, v112, v113
  v_mul_f32 v106, v113, v99
  v_mul_f32 v107, v113, v98
  v_fma_f32 v110, v112, v98, -v106
  v_fma_f32 v111, v112, v99, v107
  v_cvt_pk_bf16_f32 v160, v110, v111
  v_mul_f32 v106, v111, v99
  v_mul_f32 v107, v111, v98
  v_fma_f32 v112, v110, v98, -v106
  v_fma_f32 v113, v110, v99, v107
  v_cvt_pk_bf16_f32 v161, v112, v113
  v_mul_f32 v106, v113, v99
  v_mul_f32 v107, v113, v98
  v_fma_f32 v110, v112, v98, -v106
  v_fma_f32 v111, v112, v99, v107
  v_cvt_pk_bf16_f32 v162, v110, v111
  v_mul_f32 v106, v111, v99
  v_mul_f32 v107, v111, v98
  v_fma_f32 v112, v110, v98, -v106
  v_fma_f32 v113, v110, v99, v107
  v_cvt_pk_bf16_f32 v163, v112, v113
  v_mul_f32 v106, v113, v99
  v_mul_f32 v107, v113, v98
  v_fma_f32 v110, v112, v98, -v106
  v_fma_f32 v111, v112, v99, v107
  v_cvt_pk_bf16_f32 v164, v110, v111
  v_mul_f32 v106, v111, v99
  v_mul_f32 v107, v111, v98
  v_fma_f32 v112, v110, v98, -v106
  v_fma_f32 v113, v110, v99, v107
  v_cvt_pk_bf16_f32 v165, v112, v113
  v_mul_f32 v106, v113, v99
  v_mul_f32 v107, v113, v98
  v_fma_f32 v110, v112, v98, -v106
  v_fma_f32 v111, v112, v99, v107
  v_cvt_pk_bf16_f32 v166, v110, v111
  v_mul_f32 v106, v111, v99
  v_mul_f32 v107, v111, v98
  v_fma_f32 v112, v110, v98, -v106
  v_fma_f32 v113, v110, v99, v107
  v_cvt_pk_bf16_f32 v167, v112, v113
  v_mul_f32 v106, v113, v99
  v_mul_f32 v107, v113, v98
  v_fma_f32 v110, v112, v98, -v106
  v_fma_f32 v111, v112, v99, v107
  v_cvt_pk_bf16_f32 v168, v110, v111
  v_mul_f32 v106, v111, v99
  v_mul_f32 v107, v111, v98
  v_fma_f32 v112, v110, v98, -v106
  v_fma_f32 v113, v110, v99, v107
  v_cvt_pk_bf16_f32 v169, v112, v113
  v_mul_f32 v106, v113, v99
  v_mul_f32 v107, v113, v98
  v_fma_f32 v110, v112, v98, -v106
  v_fma_f32 v111, v112, v99, v107
  v_cvt_pk_bf16_f32 v170, v110, v111
  v_mul_f32 v106, v111, v99
  v_mul_f32 v107, v111, v98
  v_fma_f32 v112, v110, v98, -v106
  v_fma_f32 v113, v110, v99, v107
  v_cvt_pk_bf16_f32 v171, v112, v113
  v_mul_f32 v106, v113, v99
  v_mul_f32 v107, v113, v98
  v_fma_f32 v110, v112, v98, -v106
  v_fma_f32 v111, v112, v99, v107
  v_cvt_pk_bf16_f32 v172, v110, v111
  v_mul_f32 v106, v111, v99
  v_mul_f32 v107, v111, v98
  v_fma_f32 v112, v110, v98, -v106
  v_fma_f32 v113, v110, v99, v107
  v_cvt_pk_bf16_f32 v173, v112, v113
  v_mul_f32 v106, v113, v99
  v_mul_f32 v107, v113, v98
  v_fma_f32 v110, v112, v98, -v106
  v_fma_f32 v111, v112, v99, v107
  v_cvt_pk_bf16_f32 v174, v110, v111
  v_mul_f32 v106, v111, v99
  v_mul_f32 v107, v111, v98
  v_fma_f32 v112, v110, v98, -v106
  v_fma_f32 v113, v110, v99, v107
  v_cvt_pk_bf16_f32 v175, v112, v113
  v_mul_f32 v106, v113, v99
  v_mul_f32 v107, v113, v98
  v_fma_f32 v110, v112, v98, -v106
  v_fma_f32 v111, v112, v99, v107
  v_cvt_pk_bf16_f32 v176, v110, v111
  v_mul_f32 v106, v111, v99
  v_mul_f32 v107, v111, v98
  v_fma_f32 v112, v110, v98, -v106
  v_fma_f32 v113, v110, v99, v107
  v_cvt_pk_bf16_f32 v177, v112, v113
  s_mul_i32 s11, s9, 229376
  s_mul_i32 s12, s68, 28672
  s_add_u32 s11, s11, s12
  s_add_u32 s50, s11, 8388608
  s_mul_i32 s11, s8, 229376
  s_add_u32 s51, s11, s12
  s_lshr_b32 s11, s68, 1
  s_mul_i32 s11, s11, 114688
  s_sub_u32 s12, 114688, s11
  s_add_u32 s52, s50, s12
  s_add_u32 s50, s50, s11
  s_and_b32 s11, s68, 1
  s_mul_i32 s11, s11, 114688
  s_sub_u32 s12, 114688, s11
  s_add_u32 s53, s51, s12
  s_add_u32 s51, s51, s11
  s_lshl_b32 s15, s68, 11
  s_waitcnt vmcnt(0)
  s_waitcnt lgkmcnt(0)
  s_branch L_AUX2
slow_68:
  s_nop 4
  s_sleep 6
  s_load_dword s10, s[92:93], 64
  s_waitcnt lgkmcnt(0)
  s_cmp_lg_u32 s10, 0
  s_cbranch_scc1 nonced_75
  s_mov_b32 s12, 65536
nonce_74:
  s_sleep 4
  global_load_dword v45, v47, s[92:93] offset:0 sc1
  s_waitcnt vmcnt(0)
  v_readfirstlane_b32 s10, v45
  s_nop 1
  s_cmp_lg_u32 s10, 0
  s_cbranch_scc1 nonced_75
  s_sub_u32 s12, s12, 1
  s_cbranch_scc0 nonce_74
nonced_75:
  s_nop 4
  s_branch back_69
slow_70:
  s_nop 4
  s_sleep 6
  s_load_dword s10, s[92:93], 192
  s_waitcnt lgkmcnt(0)
  s_cmp_lg_u32 s10, 0
  s_cbranch_scc1 nonced_77
  s_mov_b32 s12, 65536
nonce_76:
  s_sleep 4
  global_load_dword v45, v47, s[92:93] offset:128 sc1
  s_waitcnt vmcnt(0)
  v_readfirstlane_b32 s10, v45
  s_nop 1
  s_cmp_lg_u32 s10, 0
  s_cbranch_scc1 nonced_77
  s_sub_u32 s12, s12, 1
  s_cbranch_scc0 nonce_76
nonced_77:
  s_nop 4
  s_branch back_71
cond_72:
  s_nop 4
  s_lshl_b32 s11, s94, 6
  s_add_u32 s11, s11, 14745600
  v_lshlrev_b32 v184, 14, v0
  v_add_u32 v184, s11, v184
  v_mov_b32 v185, s10
  s_mov_b32 exec_hi, 0
  global_store_dword v184, v185, s[48:49] sc1
  s_mov_b64 exec, -1
  s_nop 4
  s_branch back_73
L_XC:
  s_setprio 3
  s_lshl_b32 s97, s4, 2
  s_add_u32 s97, s97, s5
  s_sub_u32 s97, s97, 28
  v_lshlrev_b32 v60, 4, v0
  s_lshl_b32 s13, s97, 16
  s_lshl_b32 s12, s3, 14
  s_add_u32 s13, s13, s12
  s_mul_i32 s14, s3, 17152
  s_waitcnt lgkmcnt(0)
  s_mov_b32 s52, s16
  s_and_b32 s53, s17, 0xffff
  s_mov_b32 s54, 2097152
  s_mov_b32 s55, 0x00020000
  s_add_u32 m0, s14, 0
  s_add_u32 s11, s13, 0
  buffer_load_dwordx4 v60, s[52:55], s11 offen lds
  s_add_u32 m0, s14, 1056
  s_add_u32 s11, s13, 1024
  buffer_load_dwordx4 v60, s[52:55], s11 offen lds
  s_add_u32 m0, s14, 2112
  s_add_u32 s11, s13, 2048
  buffer_load_dwordx4 v60, s[52:55], s11 offen lds
  s_add_u32 m0, s14, 3168
  s_add_u32 s11, s13, 3072
  buffer_load_dwordx4 v60, s[52:55], s11 offen lds
  s_barrier
  s_add_u32 m0, s14, 4224
  s_add_u32 s11, s13, 4096
  buffer_load_dwordx4 v60, s[52:55], s11 offen lds
  s_add_u32 m0, s14, 5280
  s_add_u32 s11, s13, 5120
  buffer_load_dwordx4 v60, s[52:55], s11 offen lds
  s_add_u32 m0, s14, 6336
  s_add_u32 s11, s13, 6144
  buffer_load_dwordx4 v60, s[52:55], s11 offen lds
  s_add_u32 m0, s14, 7392
  s_add_u32 s11, s13, 7168
  buffer_load_dwordx4 v60, s[52:55], s11 offen lds
  s_add_u32 m0, s14, 8576
  s_add_u32 s11, s13, 8192
  buffer_load_dwordx4 v60, s[52:55], s11 offen lds
  s_add_u32 m0, s14, 9632
  s_add_u32 s11, s13, 9216
  buffer_load_dwordx4 v60, s[52:55], s11 offen lds
  s_add_u32 m0, s14, 10688
  s_add_u32 s11, s13, 10240
  buffer_load_dwordx4 v60, s[52:55], s11 offen lds
  s_add_u32 m0, s14, 11744
  s_add_u32 s11, s13, 11264
  buffer_load_dwordx4 v60, s[52:55], s11 offen lds
  s_add_u32 m0, s14, 12800
  s_add_u32 s11, s13, 12288
  buffer_load_dwordx4 v60, s[52:55], s11 offen lds
  s_add_u32 m0, s14, 13856
  s_add_u32 s11, s13, 13312
  buffer_load_dwordx4 v60, s[52:55], s11 offen lds
  s_add_u32 m0, s14, 14912
  s_add_u32 s11, s13, 14336
  buffer_load_dwordx4 v60, s[52:55], s11 offen lds
  s_add_u32 m0, s14, 15968
  s_add_u32 s11, s13, 15360
  buffer_load_dwordx4 v60, s[52:55], s11 offen lds
  s_mov_b32 s64, s48
  s_and_b32 s65, s49, 0xffff
  s_mov_b32 s66, 268435456
  s_mov_b32 s67, 0x00020000
  v_lshrrev_b32 v4, 4, v0
  v_bfe_u32 v5, v0, 2, 2
  v_lshl_add_u32 v5, v4, 3, v5
  v_mul_u32_u24 v5, 1056, v5
  v_lshl_add_u32 v5, v4, 7, v5
  v_and_b32 v6, 3, v0
  v_lshl_add_u32 v5, v6, 3, v5
  s_lshl_b32 s11, s3, 8
  v_add_u32 v5, s11, v5
  s_mul_i32 s11, s3, 9216
  s_add_u32 s11, s11, 81920
  v_and_b32 v6, 15, v0
  v_mul_u32_u24 v6, 144, v6
  v_lshl_add_u32 v6, v4, 4, v6
  v_add_u32 v6, s11, v6
  v_lshrrev_b32 v7, 3, v0
  v_and_b32 v8, 7, v0
  v_lshlrev_b32 v8, 4, v8
  v_mul_u32_u24 v9, 144, v7
  v_add3_u32 v9, v9, v8, s11
  v_lshl_add_u32 v7, v7, 12, v8
  s_lshl_b32 s11, s3, 19
  s_lshl_b32 s12, s97, 7
  s_add_u32 s93, s11, s12
  s_add_u32 s93, s93, 10485760
  v_mov_b32 v1, 163396
  v_mov_b32 v2, 1
  v_mov_b32 v3, 9
  s_waitcnt vmcnt(0)
  s_mov_b64 exec, 1
  ds_add_u32 v1, v2
  s_mov_b64 exec, -1
  s_mov_b32 s12, 262144
isp_78:
  ds_read_b32 v11, v1
  s_sub_u32 s12, s12, 1
  s_waitcnt lgkmcnt(0)
  v_readfirstlane_b32 s11, v11
  s_nop 0
  s_cselect_b32 s61, -1, s11
  s_cmp_lt_u32 s61, 4
  s_cbranch_scc1 isp_78
  ds_read_b64_tr_b16 v[192:193], v5 offset:0
  ds_read_b64_tr_b16 v[194:195], v5 offset:4224
  ds_read_b64_tr_b16 v[196:197], v5 offset:34304
  ds_read_b64_tr_b16 v[198:199], v5 offset:38528
  ds_read_b64_tr_b16 v[200:201], v5 offset:32
  ds_read_b64_tr_b16 v[202:203], v5 offset:4256
  ds_read_b64_tr_b16 v[204:205], v5 offset:34336
  ds_read_b64_tr_b16 v[206:207], v5 offset:38560
  ds_read_b64_tr_b16 v[208:209], v5 offset:64
  ds_read_b64_tr_b16 v[210:211], v5 offset:4288
  ds_read_b64_tr_b16 v[212:213], v5 offset:34368
  ds_read_b64_tr_b16 v[214:215], v5 offset:38592
  ds_read_b64_tr_b16 v[216:217], v5 offset:96
  ds_read_b64_tr_b16 v[218:219], v5 offset:4320
  ds_read_b64_tr_b16 v[220:221], v5 offset:34400
  ds_read_b64_tr_b16 v[222:223], v5 offset:38624
  ds_read_b64_tr_b16 v[224:225], v5 offset:128
  ds_read_b64_tr_b16 v[226:227], v5 offset:4352
  ds_read_b64_tr_b16 v[228:229], v5 offset:34432
  ds_read_b64_tr_b16 v[230:231], v5 offset:38656
  ds_read_b64_tr_b16 v[232:233], v5 offset:160
  ds_read_b64_tr_b16 v[234:235], v5 offset:4384
  ds_read_b64_tr_b16 v[236:237], v5 offset:34464
  ds_read_b64_tr_b16 v[238:239], v5 offset:38688
  ds_read_b64_tr_b16 v[240:241], v5 offset:192
  ds_read_b64_tr_b16 v[242:243], v5 offset:4416
  ds_read_b64_tr_b16 v[244:245], v5 offset:34496
  ds_read_b64_tr_b16 v[246:247], v5 offset:38720
  ds_read_b64_tr_b16 v[248:249], v5 offset:224
  ds_read_b64_tr_b16 v[250:251], v5 offset:4448
  ds_read_b64_tr_b16 v[252:253], v5 offset:34528
  ds_read_b64_tr_b16 v[254:255], v5 offset:38752
  s_waitcnt lgkmcnt(15)
  ds_write_b128 v6, v[192:195] offset:0
  ds_write_b128 v6, v[196:199] offset:64
  ds_write_b128 v6, v[200:203] offset:2304
  ds_write_b128 v6, v[204:207] offset:2368
  ds_write_b128 v6, v[208:211] offset:4608
  ds_write_b128 v6, v[212:215] offset:4672
  ds_write_b128 v6, v[216:219] offset:6912
  ds_write_b128 v6, v[220:223] offset:6976
  ds_read_b128 v[64:67], v9 offset:0
  ds_read_b128 v[68:71], v9 offset:1152
  ds_read_b128 v[72:75], v9 offset:2304
  ds_read_b128 v[76:79], v9 offset:3456
  ds_read_b128 v[80:83], v9 offset:4608
  ds_read_b128 v[84:87], v9 offset:5760
  ds_read_b128 v[88:91], v9 offset:6912
  ds_read_b128 v[92:95], v9 offset:8064
  s_waitcnt lgkmcnt(7)
  s_add_u32 s11, s93, 0
  buffer_store_dwordx4 v[64:67], v7, s[64:67], s11 offen sc1
  s_waitcnt lgkmcnt(6)
  s_add_u32 s11, s93, 32768
  buffer_store_dwordx4 v[68:71], v7, s[64:67], s11 offen sc1
  s_waitcnt lgkmcnt(5)
  s_add_u32 s11, s93, 65536
  buffer_store_dwordx4 v[72:75], v7, s[64:67], s11 offen sc1
  s_waitcnt lgkmcnt(4)
  s_add_u32 s11, s93, 98304
  buffer_store_dwordx4 v[76:79], v7, s[64:67], s11 offen sc1
  s_waitcnt lgkmcnt(3)
  s_add_u32 s11, s93, 131072
  buffer_store_dwordx4 v[80:83], v7, s[64:67], s11 offen sc1
  s_waitcnt lgkmcnt(2)
  s_add_u32 s11, s93, 163840
  buffer_store_dwordx4 v[84:87], v7, s[64:67], s11 offen sc1
  s_waitcnt lgkmcnt(1)
  s_add_u32 s11, s93, 196608
  buffer_store_dwordx4 v[88:91], v7, s[64:67], s11 offen sc1
  s_waitcnt lgkmcnt(0)
  s_add_u32 s11, s93, 229376
  buffer_store_dwordx4 v[92:95], v7, s[64:67], s11 offen sc1
  ds_write_b128 v6, v[224:227] offset:0
  ds_write_b128 v6, v[228:231] offset:64
  ds_write_b128 v6, v[232:235] offset:2304
  ds_write_b128 v6, v[236:239] offset:2368
  ds_write_b128 v6, v[240:243] offset:4608
  ds_write_b128 v6, v[244:247] offset:4672
  ds_write_b128 v6, v[248:251] offset:6912
  ds_write_b128 v6, v[252:255] offset:6976
  ds_read_b128 v[96:99], v9 offset:0
  ds_read_b128 v[100:103], v9 offset:1152
  ds_read_b128 v[104:107], v9 offset:2304
  ds_read_b128 v[108:111], v9 offset:3456
  ds_read_b128 v[112:115], v9 offset:4608
  ds_read_b128 v[116:119], v9 offset:5760
  ds_read_b128 v[120:123], v9 offset:6912
  ds_read_b128 v[124:127], v9 offset:8064
  s_waitcnt lgkmcnt(7)
  s_add_u32 s11, s93, 262144
  buffer_store_dwordx4 v[96:99], v7, s[64:67], s11 offen sc1
  s_waitcnt lgkmcnt(6)
  s_add_u32 s11, s93, 294912
  buffer_store_dwordx4 v[100:103], v7, s[64:67], s11 offen sc1
  s_waitcnt lgkmcnt(5)
  s_add_u32 s11, s93, 327680
  buffer_store_dwordx4 v[104:107], v7, s[64:67], s11 offen sc1
  s_waitcnt lgkmcnt(4)
  s_add_u32 s11, s93, 360448
  buffer_store_dwordx4 v[108:111], v7, s[64:67], s11 offen sc1
  s_waitcnt lgkmcnt(3)
  s_add_u32 s11, s93, 393216
  buffer_store_dwordx4 v[112:115], v7, s[64:67], s11 offen sc1
  s_waitcnt lgkmcnt(2)
  s_add_u32 s11, s93, 425984
  buffer_store_dwordx4 v[116:119], v7, s[64:67], s11 offen sc1
  s_waitcnt lgkmcnt(1)
  s_add_u32 s11, s93, 458752
  buffer_store_dwordx4 v[120:123], v7, s[64:67], s11 offen sc1
  s_waitcnt lgkmcnt(0)
  s_add_u32 s11, s93, 491520
  buffer_store_dwordx4 v[124:127], v7, s[64:67], s11 offen sc1
  s_mov_b64 exec, 1
  ds_add_u32 v1, v3
  s_mov_b64 exec, -1
  v_mov_b32 v14, 163392
  s_mov_b32 s12, 262144
isp_79:
  s_sleep 1
  ds_read_b32 v15, v14
  s_sub_u32 s12, s12, 1
  s_waitcnt lgkmcnt(0)
  v_readfirstlane_b32 s11, v15
  s_nop 0
  s_cselect_b32 s61, -1, s11
  s_cmp_lt_u32 s61, 1
  s_cbranch_scc1 isp_79
  s_mov_b32 s10, s11
  s_waitcnt vmcnt(0)
  s_mov_b32 s13, 128
  v_mov_b32 v12, 163420
  v_mov_b32 v13, 1
  s_mov_b64 exec, 1
  ds_add_rtn_u32 v13, v12, v13
  s_waitcnt lgkmcnt(0)
  v_readfirstlane_b32 s12, v13
  s_mov_b64 exec, -1
  s_cmp_eq_u32 s12, 3
  s_cbranch_scc1 cond_80
back_81:
  s_setprio 2
  v_lshlrev_b32 v60, 4, v0
  s_mul_i32 s11, s9, 229376
  s_mul_i32 s12, s3, 28672
  s_add_u32 s11, s11, s12
  s_add_u32 s50, s11, 8388608
  s_mul_i32 s11, s8, 229376
  s_add_u32 s51, s11, s12
  s_lshr_b32 s11, s3, 1
  s_mul_i32 s11, s11, 114688
  s_sub_u32 s12, 114688, s11
  s_add_u32 s52, s50, s12
  s_add_u32 s50, s50, s11
  s_and_b32 s11, s3, 1
  s_mul_i32 s11, s11, 114688
  s_sub_u32 s12, 114688, s11
  s_add_u32 s53, s51, s12
  s_add_u32 s51, s51, s11
  s_lshl_b32 s11, s3, 2
  s_add_u32 s11, s11, 163472
  v_mov_b32 v14, s11
  v_mov_b32 v15, 2
  ds_write_b32 v14, v15
  s_lshl_b32 s94, s9, 2
  s_add_u32 s94, s94, s3
  s_add_u32 s94, s94, 137
  v_mov_b32 v14, 163412
  s_mov_b32 s12, 262144
isp_82:
  s_sleep 4
  ds_read_b32 v15, v14
  s_sub_u32 s12, s12, 1
  s_waitcnt lgkmcnt(0)
  v_readfirstlane_b32 s11, v15
  s_nop 0
  s_cselect_b32 s61, -1, s11
  s_cmp_lt_u32 s61, 4
  s_cbranch_scc1 isp_82
  s_waitcnt lgkmcnt(0)
  s_lshl_b32 s62, s94, 6
  s_add_u32 s62, s62, 15007744
  s_mov_b32 s63, 16
sw_83:
  s_load_dword s60, s[48:49], s62
  s_waitcnt lgkmcnt(0)
  s_cmp_eq_u32 s60, s10
  s_cbranch_scc1 swd_84
  s_sleep 8
  s_add_u32 s62, s62, 16384
  s_sub_u32 s63, s63, 1
  s_cmp_lg_u32 s63, 0
  s_cbranch_scc1 sw_83
  s_sub_u32 s62, s62, 16384
  v_mov_b32 v14, s62
  s_mov_b32 s12, 65536
poll_85:
  global_load_dword v15, v14, s[48:49] sc1
  s_waitcnt vmcnt(0)
  v_cmp_ne_u32 vcc, s10, v15
  s_nop 0
  s_cmp_eq_u64 vcc, 0
  s_cbranch_scc1 polld_86
  s_sleep 8
  s_sub_u32 s12, s12, 1
  s_cbranch_scc0 poll_85
polld_86:
swd_84:
  s_branch L_G2JOIN
cond_80:
  s_nop 4
  s_lshl_b32 s11, s13, 7
  s_add_u32 s11, s11, 15269888
  v_mov_b32 v12, s11
  v_mov_b32 v13, 1
  s_mov_b64 exec, 1
  global_atomic_add v13, v12, v13, s[48:49] sc0 sc1
  s_mov_b64 exec, -1
  s_waitcnt vmcnt(0)
  v_readfirstlane_b32 s12, v13
  s_nop 0
  s_cmp_lg_u32 s12, 31
  s_cbranch_scc1 ca_87
  s_lshl_b32 s11, s13, 6
  s_add_u32 s11, s11, 14745600
  v_lshlrev_b32 v12, 14, v0
  v_add_u32 v12, s11, v12
  v_mov_b32 v13, s10
  s_mov_b32 exec_hi, 0
  global_store_dword v12, v13, s[48:49] sc1
  s_mov_b64 exec, -1
ca_87:
  s_nop 4
  s_branch back_81
L_END:
  s_endpgm
.section .rodata,"a"
.p2align 6
.amdhsa_kernel parallel_sum__ssm_conv_s4__dense_activation_gelu__prompt_kernel
  .amdhsa_next_free_vgpr 256
  .amdhsa_next_free_sgpr 102
  .amdhsa_accum_offset 256
  .amdhsa_group_segment_fixed_size 0
  .amdhsa_kernarg_size 136
  .amdhsa_user_sgpr_count 2
  .amdhsa_user_sgpr_kernarg_segment_ptr 1
  .amdhsa_system_sgpr_workgroup_id_x 1
.end_amdhsa_kernel
```
